```python
import torch

def _softmax(x, axis=-1):
    return torch.softmax(x, dim=axis)
def _gelu(x):
    return torch.nn.functional.gelu(x, approximate="tanh")
def _silu(x):
    return torch.nn.functional.silu(x)
def _sigmoid(x):
    return torch.sigmoid(x)
def _layernorm(x, axis=-1, eps=1e-5):
    m = x.mean(dim=axis, keepdim=True)
    v = x.var(dim=axis, keepdim=True, unbiased=False)
    return (x - m) / torch.sqrt(v + eps)
def _scatter_add(tgt, idx, src, axis=0):
    return tgt.clone().index_add_(axis, idx, src)
def _segment_sum(src, seg, n):
    out = torch.zeros((n,) + src.shape[1:], dtype=src.dtype)
    return out.index_add_(0, seg, src)
def _pad(x, pw):
    flat = tuple(v for pair in reversed(pw) for v in pair)
    return torch.nn.functional.pad(x, flat)

kernel_name = 'gated_mix__mha_block__linear_attn_block__prompt'

def setup_inputs():

    _w = (lambda a: (lambda t: t.to(torch.bfloat16) if t.is_floating_point() else t)(torch.as_tensor(a)))
    def _A_setup():
        B, S, D, H = 1, 2048, 512, 32
        return {
            "x": _w((lambda *s: torch.randn(*s, dtype=torch.bfloat16) * 0.05)(B, S, D)),
            "wqkv": _w((lambda *s: torch.randn(*s, dtype=torch.bfloat16) * 0.8)(D, 3 * D)),
            "wo": _w((lambda *s: torch.randn(*s, dtype=torch.bfloat16) * 0.05)(D, D)),
        }
    _A_in = _A_setup()

    def _B_setup():
        B, S, D = 1, 2048, 512
        return {
            "x": _w((lambda *s: torch.randn(*s, dtype=torch.bfloat16) * 0.05)(B, S, D)),
            "wqkv": _w((lambda *s: torch.randn(*s, dtype=torch.bfloat16) * 0.8)(D, 3 * D)),
            "wo": _w((lambda *s: torch.randn(*s, dtype=torch.bfloat16) * 0.2)(D, D)),
        }
    _B_in = _B_setup()

    return {
        "A_x": _A_in["x"],
        "A_wqkv": _A_in["wqkv"],
        "A_wo": _A_in["wo"],
        "B_x": _B_in["x"],
        "B_wqkv": _B_in["wqkv"],
        "B_wo": _B_in["wo"],
        "gate_w": _w((lambda *s: torch.randn(*s, dtype=torch.bfloat16) * 0.05)(512) * 16.0),
    }

def reference(A_x, A_wqkv, A_wo, B_x, B_wqkv, B_wo, gate_w):
    def _A_ref(x, wqkv, wo):
        B, S, D = x.shape
        H = 32
        Dh = D // H
        qkv = (lambda x, *d: x.permute(*d))((x @ wqkv).reshape(B, S, 3, H, Dh), 2, 0, 3, 1, 4)
        q, k, v = qkv[0], qkv[1], qkv[2]
        scores = torch.einsum("bhqd,bhkd->bhqk", q, k) * (Dh ** -0.5)
        p = _softmax(scores, axis=-1)
        o = torch.einsum("bhqk,bhkd->bhqd", p, v)
        return (lambda x, *d: x.permute(*d))(o, 0, 2, 1, 3).reshape(B, S, D) @ wo

    def _B_ref(x, wqkv, wo):
        B, S, D = x.shape
        H = 32; Dh = D // H
        qkv = (lambda x, *d: x.permute(*d))((x @ wqkv).reshape(B, S, 3, H, Dh), 2, 0, 3, 1, 4)
        q, k, v = qkv[0], qkv[1], qkv[2]
        phi = lambda t: torch.where(t > 0, t + 1, torch.exp(t)) + 1e-6
        pq, pk = phi(q), phi(k)
        kv = torch.einsum("bhsd,bhse->bhde", pk, v)
        z = torch.einsum("bhsd->bhd", pk)
        num = torch.einsum("bhqd,bhde->bhqe", pq, kv)
        den = torch.einsum("bhqd,bhd->bhq", pq, z)[..., None] + 1e-6
        o = num / den
        return (lambda x, *d: x.permute(*d))(o, 0, 2, 1, 3).reshape(B, S, D) @ wo

    x = A_x
    g = _sigmoid((x * gate_w).sum(-1, keepdims=True))
    a = _A_ref(x, A_wqkv, A_wo)
    b = _B_ref(x, B_wqkv, B_wo)
    return g * a + (1 - g) * b
```

```asm
; @launch grid=(256,1,1) block=(512,1,1) lds=163840
.amdgcn_target "amdgcn-amd-amdhsa--gfx950"
.text
.globl gated_mix__mha_block__linear_attn_block__prompt_kernel
.p2align 8
.type gated_mix__mha_block__linear_attn_block__prompt_kernel,@function
gated_mix__mha_block__linear_attn_block__prompt_kernel:
    s_cmp_ge_u32 s2, 256
    s_cbranch_scc1 L_done
    s_load_dwordx16 s[36:51], s[0:1], 0
    s_load_dwordx4 s[52:55], s[0:1], 64
    s_getpc_b64 s[60:61]
L_pc:
    v_lshlrev_b32 v2, 7, v0
    v_min_u32 v2, 0x7a54, v2
    v_mov_b32 v3, s61
    v_add_co_u32 v2, vcc, s60, v2
    s_nop 1
    v_addc_co_u32 v3, vcc, 0, v3, vcc
    global_load_dword v229, v[2:3], off
    v_lshrrev_b32 v1, 6, v0
    v_and_b32 v0, 63, v0
    v_readfirstlane_b32 s33, v1
    s_and_b32 s28, s2, 7
    s_lshr_b32 s29, s2, 3
    s_and_b32 s67, s28, 1
    s_lshl_b32 s67, s67, 3
    s_and_b32 s69, s29, 7
    s_add_u32 s67, s67, s69
    s_and_b32 s66, s28, 6
    s_lshr_b32 s30, s29, 4
    s_add_u32 s66, s66, s30
    s_bfe_u32 s76, s2, 0x10006
    s_and_b32 s34, s33, 3
    v_lshlrev_b32 v1, 4, v0
    s_cmp_lt_u32 s33, 4
    s_cbranch_scc1 L_mm
    v_lshrrev_b32 v16, 3, v0
    v_lshrrev_b32 v17, 4, v0
    v_and_b32 v18, 7, v0
    v_xor_b32 v19, v18, v17
    v_lshlrev_b32 v19, 4, v19
    s_lshl_b32 s28, s67, 2
    s_add_u32 s28, s28, s34
    s_lshl_b32 s28, s28, 15
    v_lshl_add_u32 v8, v16, 10, v19
    v_add_u32 v8, s28, v8
    v_xor_b32 v9, 64, v8
    v_add_u32 v9, 0x2000, v9
    v_add_u32 v10, 0x4000, v8
    v_add_u32 v11, 0x4000, v9
    v_and_b32 v17, 1, v17
    v_lshlrev_b32 v17, 2, v17
    v_xor_b32 v18, v18, v17
    v_lshlrev_b32 v18, 4, v18
    v_mul_u32_u24 v12, 0xc00, v16
    v_add_u32 v12, v12, v18
    s_mul_i32 s28, s34, 24576
    v_add_u32 v12, s28, v12
    s_lshl_b32 s30, s34, 12
    s_lshl_b32 s31, s34, 10
    s_cmp_eq_u32 s76, 1
    s_cselect_b32 s28, 8, 0
    s_cselect_b32 s29, 0, 0
    s_xor_b32 s29, s29, s66
    s_add_u32 s28, s28, s29
    s_lshl_b32 s14, s28, 7
    s_mov_b32 s15, 0x00020000
    s_cmp_eq_u32 s76, 1
    s_cselect_b32 s28, 16, 8
    s_cselect_b32 s29, 0, 4
    s_xor_b32 s29, s29, s66
    s_add_u32 s28, s28, s29
    s_lshl_b32 s18, s28, 7
    s_mov_b32 s19, 0x00020000
    s_cmp_eq_u32 s76, 1
    s_cselect_b32 s28, 0, 16
    s_cselect_b32 s29, 4, 4
    s_xor_b32 s29, s29, s66
    s_add_u32 s28, s28, s29
    s_lshl_b32 s22, s28, 7
    s_mov_b32 s23, 0x00020000
    s_waitcnt lgkmcnt(0)
    s_mov_b32 s8, s36
    s_mov_b32 s9, s37
    s_mov_b32 s10, 0x200000
    s_mov_b32 s11, 0x00020000
    s_add_u32 s3, s69, 0
    s_and_b32 s3, s3, 7
    s_lshl_b32 s28, s3, 7
    s_add_u32 m0, s30, 0
    s_nop 0
    buffer_load_dwordx4 v8, s[8:11], s28 offen lds
    s_add_u32 m0, s30, 1024
    s_nop 0
    buffer_load_dwordx4 v9, s[8:11], s28 offen lds
    s_add_u32 m0, s30, 2048
    s_nop 0
    buffer_load_dwordx4 v10, s[8:11], s28 offen lds
    s_add_u32 m0, s30, 3072
    s_nop 0
    buffer_load_dwordx4 v11, s[8:11], s28 offen lds
    s_add_u32 s12, s38, s14
    s_addc_u32 s13, s39, 0
    s_sub_u32 s14, 0x180000, s14
    s_cmp_eq_u32 s76, 1
    s_cselect_b32 s16, s38, s44
    s_cselect_b32 s17, s39, s45
    s_add_u32 s16, s16, s18
    s_addc_u32 s17, s17, 0
    s_sub_u32 s18, 0x180000, s18
    s_add_u32 s3, s69, 0
    s_and_b32 s3, s3, 7
    s_mul_i32 s29, s3, 0x30000
    s_add_u32 m0, s31, 131072
    s_add_u32 s28, s29, 0x0
    buffer_load_dwordx4 v12, s[12:15], s28 offen lds
    s_add_u32 m0, s31, 135168
    s_add_u32 s28, s29, 0x0
    buffer_load_dwordx4 v12, s[16:19], s28 offen lds
    s_add_u32 s3, s69, 0
    s_and_b32 s3, s3, 7
    s_mul_i32 s29, s3, 0x30000
    s_add_u32 m0, s31, 139264
    s_add_u32 s28, s29, 0x18000
    buffer_load_dwordx4 v12, s[12:15], s28 offen lds
    s_add_u32 m0, s31, 143360
    s_add_u32 s28, s29, 0x18000
    buffer_load_dwordx4 v12, s[16:19], s28 offen lds
    s_add_u32 s20, s44, s22
    s_addc_u32 s21, s45, 0
    s_sub_u32 s22, 0x180000, s22
    s_add_u32 s3, s69, 1
    s_and_b32 s3, s3, 7
    s_lshl_b32 s28, s3, 7
    s_add_u32 m0, s30, 16384
    s_nop 0
    buffer_load_dwordx4 v8, s[8:11], s28 offen lds
    s_add_u32 m0, s30, 17408
    s_nop 0
    buffer_load_dwordx4 v9, s[8:11], s28 offen lds
    s_add_u32 m0, s30, 18432
    s_nop 0
    buffer_load_dwordx4 v10, s[8:11], s28 offen lds
    s_add_u32 m0, s30, 19456
    s_nop 0
    buffer_load_dwordx4 v11, s[8:11], s28 offen lds
    s_mov_b32 s24, s54
    s_mov_b32 s25, s55
    s_mov_b32 s26, 0x1000000
    s_mov_b32 s27, 0x00020000
    s_mov_b32 s4, s52
    s_mov_b32 s5, s53
    s_mov_b32 s6, 0x100
    s_mov_b32 s7, 0x00020000
    v_mov_b32 v13, 0
    s_sub_u32 s28, s33, 4
    s_or_b32 s28, s28, s2
    s_cbranch_scc1 L_notag
    s_memrealtime s[56:57]
    s_waitcnt lgkmcnt(0)
    s_or_b32 s56, s56, 1
    s_or_b32 s57, s57, 0x40000000
    v_mov_b32 v46, s56
    v_mov_b32 v47, s57
    s_mov_b64 exec, 1
    buffer_store_dwordx2 v[46:47], v13, s[4:7], 0 offen sc1
    s_mov_b64 exec, -1
L_notag:
    s_add_u32 s3, s69, 1
    s_and_b32 s3, s3, 7
    s_mul_i32 s29, s3, 0x30000
    s_add_u32 m0, s31, 147456
    s_add_u32 s28, s29, 0x0
    buffer_load_dwordx4 v12, s[12:15], s28 offen lds
    s_add_u32 m0, s31, 151552
    s_add_u32 s28, s29, 0x0
    buffer_load_dwordx4 v12, s[16:19], s28 offen lds
    s_waitcnt vmcnt(8)
    s_barrier
    s_add_u32 s3, s69, 1
    s_and_b32 s3, s3, 7
    s_mul_i32 s29, s3, 0x30000
    s_add_u32 m0, s31, 155648
    s_add_u32 s28, s29, 0x18000
    buffer_load_dwordx4 v12, s[12:15], s28 offen lds
    s_add_u32 m0, s31, 159744
    s_add_u32 s28, s29, 0x18000
    buffer_load_dwordx4 v12, s[16:19], s28 offen lds
    s_add_u32 s3, s69, 2
    s_and_b32 s3, s3, 7
    s_lshl_b32 s28, s3, 7
    s_add_u32 m0, s30, 32768
    s_nop 0
    buffer_load_dwordx4 v8, s[8:11], s28 offen lds
    s_add_u32 m0, s30, 33792
    s_nop 0
    buffer_load_dwordx4 v9, s[8:11], s28 offen lds
    s_add_u32 m0, s30, 34816
    s_nop 0
    buffer_load_dwordx4 v10, s[8:11], s28 offen lds
    s_add_u32 m0, s30, 35840
    s_nop 0
    buffer_load_dwordx4 v11, s[8:11], s28 offen lds
    s_waitcnt vmcnt(12)
    s_barrier
    s_add_u32 s3, s69, 2
    s_and_b32 s3, s3, 7
    s_mul_i32 s29, s3, 0x30000
    s_add_u32 m0, s31, 131072
    s_add_u32 s28, s29, 0x0
    buffer_load_dwordx4 v12, s[12:15], s28 offen lds
    s_add_u32 m0, s31, 135168
    s_add_u32 s28, s29, 0x0
    buffer_load_dwordx4 v12, s[16:19], s28 offen lds
    s_waitcnt vmcnt(8)
    s_barrier
    s_add_u32 s3, s69, 2
    s_and_b32 s3, s3, 7
    s_mul_i32 s29, s3, 0x30000
    s_add_u32 m0, s31, 139264
    s_add_u32 s28, s29, 0x18000
    buffer_load_dwordx4 v12, s[12:15], s28 offen lds
    s_add_u32 m0, s31, 143360
    s_add_u32 s28, s29, 0x18000
    buffer_load_dwordx4 v12, s[16:19], s28 offen lds
    s_add_u32 s3, s69, 3
    s_and_b32 s3, s3, 7
    s_lshl_b32 s28, s3, 7
    s_add_u32 m0, s30, 49152
    s_nop 0
    buffer_load_dwordx4 v8, s[8:11], s28 offen lds
    s_add_u32 m0, s30, 50176
    s_nop 0
    buffer_load_dwordx4 v9, s[8:11], s28 offen lds
    s_add_u32 m0, s30, 51200
    s_nop 0
    buffer_load_dwordx4 v10, s[8:11], s28 offen lds
    s_add_u32 m0, s30, 52224
    s_nop 0
    buffer_load_dwordx4 v11, s[8:11], s28 offen lds
    s_waitcnt vmcnt(12)
    s_barrier
    s_add_u32 s3, s69, 3
    s_and_b32 s3, s3, 7
    s_mul_i32 s29, s3, 0x30000
    s_add_u32 m0, s31, 147456
    s_add_u32 s28, s29, 0x0
    buffer_load_dwordx4 v12, s[12:15], s28 offen lds
    s_add_u32 m0, s31, 151552
    s_add_u32 s28, s29, 0x0
    buffer_load_dwordx4 v12, s[16:19], s28 offen lds
    s_waitcnt vmcnt(8)
    s_barrier
    s_add_u32 s3, s69, 3
    s_and_b32 s3, s3, 7
    s_mul_i32 s29, s3, 0x30000
    s_add_u32 m0, s31, 155648
    s_add_u32 s28, s29, 0x18000
    buffer_load_dwordx4 v12, s[12:15], s28 offen lds
    s_add_u32 m0, s31, 159744
    s_add_u32 s28, s29, 0x18000
    buffer_load_dwordx4 v12, s[16:19], s28 offen lds
    s_add_u32 s3, s69, 4
    s_and_b32 s3, s3, 7
    s_lshl_b32 s28, s3, 7
    s_add_u32 m0, s30, 65536
    s_nop 0
    buffer_load_dwordx4 v8, s[8:11], s28 offen lds
    s_add_u32 m0, s30, 66560
    s_nop 0
    buffer_load_dwordx4 v9, s[8:11], s28 offen lds
    s_add_u32 m0, s30, 67584
    s_nop 0
    buffer_load_dwordx4 v10, s[8:11], s28 offen lds
    s_add_u32 m0, s30, 68608
    s_nop 0
    buffer_load_dwordx4 v11, s[8:11], s28 offen lds
    s_waitcnt vmcnt(12)
    s_barrier
    s_add_u32 s3, s69, 4
    s_and_b32 s3, s3, 7
    s_mul_i32 s29, s3, 0x30000
    s_add_u32 m0, s31, 131072
    s_add_u32 s28, s29, 0x0
    buffer_load_dwordx4 v12, s[12:15], s28 offen lds
    s_add_u32 m0, s31, 135168
    s_add_u32 s28, s29, 0x0
    buffer_load_dwordx4 v12, s[16:19], s28 offen lds
    s_waitcnt vmcnt(8)
    s_barrier
    s_add_u32 s3, s69, 4
    s_and_b32 s3, s3, 7
    s_mul_i32 s29, s3, 0x30000
    s_add_u32 m0, s31, 139264
    s_add_u32 s28, s29, 0x18000
    buffer_load_dwordx4 v12, s[12:15], s28 offen lds
    s_add_u32 m0, s31, 143360
    s_add_u32 s28, s29, 0x18000
    buffer_load_dwordx4 v12, s[16:19], s28 offen lds
    s_add_u32 s3, s69, 5
    s_and_b32 s3, s3, 7
    s_lshl_b32 s28, s3, 7
    s_add_u32 m0, s30, 81920
    s_nop 0
    buffer_load_dwordx4 v8, s[8:11], s28 offen lds
    s_add_u32 m0, s30, 82944
    s_nop 0
    buffer_load_dwordx4 v9, s[8:11], s28 offen lds
    s_add_u32 m0, s30, 83968
    s_nop 0
    buffer_load_dwordx4 v10, s[8:11], s28 offen lds
    s_add_u32 m0, s30, 84992
    s_nop 0
    buffer_load_dwordx4 v11, s[8:11], s28 offen lds
    s_waitcnt vmcnt(12)
    s_barrier
    s_add_u32 s3, s69, 5
    s_and_b32 s3, s3, 7
    s_mul_i32 s29, s3, 0x30000
    s_add_u32 m0, s31, 147456
    s_add_u32 s28, s29, 0x0
    buffer_load_dwordx4 v12, s[12:15], s28 offen lds
    s_add_u32 m0, s31, 151552
    s_add_u32 s28, s29, 0x0
    buffer_load_dwordx4 v12, s[16:19], s28 offen lds
    s_waitcnt vmcnt(8)
    s_barrier
    s_add_u32 s3, s69, 5
    s_and_b32 s3, s3, 7
    s_mul_i32 s29, s3, 0x30000
    s_add_u32 m0, s31, 155648
    s_add_u32 s28, s29, 0x18000
    buffer_load_dwordx4 v12, s[12:15], s28 offen lds
    s_add_u32 m0, s31, 159744
    s_add_u32 s28, s29, 0x18000
    buffer_load_dwordx4 v12, s[16:19], s28 offen lds
    s_add_u32 s3, s69, 6
    s_and_b32 s3, s3, 7
    s_lshl_b32 s28, s3, 7
    s_add_u32 m0, s30, 98304
    s_nop 0
    buffer_load_dwordx4 v8, s[8:11], s28 offen lds
    s_add_u32 m0, s30, 99328
    s_nop 0
    buffer_load_dwordx4 v9, s[8:11], s28 offen lds
    s_add_u32 m0, s30, 100352
    s_nop 0
    buffer_load_dwordx4 v10, s[8:11], s28 offen lds
    s_add_u32 m0, s30, 101376
    s_nop 0
    buffer_load_dwordx4 v11, s[8:11], s28 offen lds
    s_waitcnt vmcnt(12)
    s_barrier
    s_add_u32 s3, s69, 6
    s_and_b32 s3, s3, 7
    s_mul_i32 s29, s3, 0x30000
    s_add_u32 m0, s31, 131072
    s_add_u32 s28, s29, 0x0
    buffer_load_dwordx4 v12, s[12:15], s28 offen lds
    s_add_u32 m0, s31, 135168
    s_add_u32 s28, s29, 0x0
    buffer_load_dwordx4 v12, s[16:19], s28 offen lds
    s_waitcnt vmcnt(8)
    s_barrier
    s_add_u32 s3, s69, 6
    s_and_b32 s3, s3, 7
    s_mul_i32 s29, s3, 0x30000
    s_add_u32 m0, s31, 139264
    s_add_u32 s28, s29, 0x18000
    buffer_load_dwordx4 v12, s[12:15], s28 offen lds
    s_add_u32 m0, s31, 143360
    s_add_u32 s28, s29, 0x18000
    buffer_load_dwordx4 v12, s[16:19], s28 offen lds
    s_add_u32 s3, s69, 7
    s_and_b32 s3, s3, 7
    s_lshl_b32 s28, s3, 7
    s_add_u32 m0, s30, 114688
    s_nop 0
    buffer_load_dwordx4 v8, s[8:11], s28 offen lds
    s_add_u32 m0, s30, 115712
    s_nop 0
    buffer_load_dwordx4 v9, s[8:11], s28 offen lds
    s_add_u32 m0, s30, 116736
    s_nop 0
    buffer_load_dwordx4 v10, s[8:11], s28 offen lds
    s_add_u32 m0, s30, 117760
    s_nop 0
    buffer_load_dwordx4 v11, s[8:11], s28 offen lds
    s_waitcnt vmcnt(12)
    s_barrier
    s_add_u32 s3, s69, 7
    s_and_b32 s3, s3, 7
    s_mul_i32 s29, s3, 0x30000
    s_add_u32 m0, s31, 147456
    s_add_u32 s28, s29, 0x0
    buffer_load_dwordx4 v12, s[12:15], s28 offen lds
    s_add_u32 m0, s31, 151552
    s_add_u32 s28, s29, 0x0
    buffer_load_dwordx4 v12, s[16:19], s28 offen lds
    s_waitcnt vmcnt(8)
    s_barrier
    s_add_u32 s3, s69, 7
    s_and_b32 s3, s3, 7
    s_mul_i32 s29, s3, 0x30000
    s_add_u32 m0, s31, 155648
    s_add_u32 s28, s29, 0x18000
    buffer_load_dwordx4 v12, s[12:15], s28 offen lds
    s_add_u32 m0, s31, 159744
    s_add_u32 s28, s29, 0x18000
    buffer_load_dwordx4 v12, s[16:19], s28 offen lds
    s_waitcnt vmcnt(8)
    s_barrier
    s_add_u32 s3, s69, 0
    s_and_b32 s3, s3, 7
    s_mul_i32 s29, s3, 0x30000
    s_add_u32 m0, s31, 131072
    s_add_u32 s28, s29, 0x0
    buffer_load_dwordx4 v12, s[20:23], s28 offen lds
    s_add_u32 m0, s31, 135168
    s_add_u32 s28, s29, 0x18000
    buffer_load_dwordx4 v12, s[20:23], s28 offen lds
    s_and_b32 s28, s2, 7
    s_lshl_b32 s35, s28, 2
    s_bfe_u32 s28, s2, 0x20003
    s_add_u32 s35, s35, s28
    s_lshr_b32 s64, s2, 5
    s_lshl_b32 s68, s2, 11
    s_add_u32 s68, s68, 0xa40000
    s_lshl_b32 s65, s64, 3
    s_add_u32 s65, s65, s33
    v_and_b32 v4, 15, v0
    v_lshlrev_b32 v4, 4, v4
    v_lshrrev_b32 v16, 5, v0
    v_lshl_add_u32 v4, v16, 8, v4
    v_add_u32 v4, 0x10000, v4
    v_lshrrev_b32 v17, 3, v0
    v_bfe_u32 v18, v0, 4, 1
    v_lshlrev_b32 v19, 2, v18
    v_and_b32 v5, 7, v0
    v_xor_b32 v5, v5, v19
    v_lshlrev_b32 v5, 4, v5
    v_lshl_add_u32 v5, v17, 10, v5
    v_bfe_u32 v17, v0, 2, 2
    v_lshlrev_b32 v6, 7, v17
    v_lshl_add_u32 v6, v16, 9, v6
    v_lshrrev_b32 v17, 1, v17
    v_lshl_add_u32 v6, v17, 6, v6
    v_lshl_add_u32 v6, v18, 5, v6
    v_and_b32 v17, 1, v0
    v_lshl_add_u32 v6, v17, 4, v6
    v_bfe_u32 v18, v0, 1, 1
    v_lshl_add_u32 v6, v18, 3, v6
    v_and_b32 v17, 7, v0
    v_lshlrev_b32 v14, 14, v17
    s_lshl_b32 s70, s33, 10
    s_and_b32 s71, s33, 1
    s_lshr_b32 s72, s33, 1
    s_bfe_u32 s73, s2, 0x30003
    s_lshl_b32 s28, s35, 16
    s_add_u32 s78, s28, s70
    s_lshl_b32 s29, s65, 10
    s_add_u32 s79, s28, s29
    s_add_u32 s79, s79, 0x600000
    s_lshl_b32 s29, s72, 13
    s_add_u32 s42, s28, s29
    s_lshl_b32 s29, s71, 10
    s_add_u32 s42, s42, s29
    s_add_u32 s42, s42, 0x800000
    s_lshl_b32 s28, s65, 16
    s_lshl_b32 s29, s35, 10
    s_add_u32 s43, s28, s29
    s_add_u32 s43, s43, 0xb00000
    s_lshl_b32 s49, s65, 7
    s_add_u32 s49, s49, 0xa00000
    s_lshl_b32 s28, s33, 16
    s_lshl_b32 s29, s73, 7
    s_add_u32 s37, s28, s29
    s_lshl_b32 s48, s33, 13
    s_and_b32 s28, s48, 0x8000
    s_add_u32 s48, s48, s28
    s_andn2_b32 s28, s48, 0x2000
    v_add_u32 v6, s28, v6
    s_cmp_eq_u32 s72, 1
    s_cselect_b32 s53, 5, 4
    s_cmp_eq_u32 s72, 0
    s_cselect_b32 s53, 2, s53
    s_lshl_b32 s53, s53, 14
    v_xor_b32 v7, 64, v6
    s_lshr_b32 s28, s2, 6
    s_lshl_b32 s28, s28, 1
    s_add_u32 s28, s28, s71
    s_and_b32 s29, s2, 7
    s_lshl_b32 s29, s29, 3
    s_add_u32 s74, s28, s29
    s_lshl_b32 s28, s74, 16
    s_lshl_b32 s29, s72, 13
    s_add_u32 s36, s28, s29
    s_add_u32 s36, s36, 0xb00000
    s_lshl_b32 s29, s72, 6
    s_add_u32 s28, s64, s29
    s_lshl_b32 s28, s28, 11
    s_lshl_b32 s29, s71, 5
    s_add_u32 s29, s29, s35
    s_lshl_b32 s29, s29, 3
    s_add_u32 s28, s28, s29
    s_add_u32 s77, s28, 0xa40000
    s_lshl_b32 s28, s71, 8
    s_lshl_b32 s29, s72, 6
    s_add_u32 s28, s28, s29
    s_add_u32 s75, s28, s68
    s_mov_b32 s58, 0xffff
    s_mov_b32 s59, 0xffff
    s_mov_b32 s54, 0
    s_mov_b32 s52, 0
    v_lshlrev_b32 v226, 14, v0
    s_xor_b32 s28, s66, 4
    s_lshl_b32 s28, s28, 11
    s_lshl_b32 s29, s76, 4
    s_add_u32 s29, s29, s67
    s_lshl_b32 s29, s29, 3
    s_add_u32 s28, s28, s29
    s_add_u32 s55, s28, 0xa40000
    s_lshl_b32 s28, s64, 1
    s_lshl_b32 s60, 3, s28
    s_or_b32 s60, s60, 0xffff0000
    s_mov_b32 s61, 0
    s_waitcnt vmcnt(4)
    s_barrier
    s_add_u32 s3, s69, 1
    s_and_b32 s3, s3, 7
    s_mul_i32 s29, s3, 0x30000
    s_add_u32 m0, s31, 139264
    s_add_u32 s28, s29, 0x0
    buffer_load_dwordx4 v12, s[20:23], s28 offen lds
    s_add_u32 m0, s31, 143360
    s_add_u32 s28, s29, 0x18000
    buffer_load_dwordx4 v12, s[20:23], s28 offen lds
    s_waitcnt vmcnt(4)
    s_barrier
    s_add_u32 s3, s69, 2
    s_and_b32 s3, s3, 7
    s_mul_i32 s29, s3, 0x30000
    s_add_u32 m0, s31, 147456
    s_add_u32 s28, s29, 0x0
    buffer_load_dwordx4 v12, s[20:23], s28 offen lds
    s_add_u32 m0, s31, 151552
    s_add_u32 s28, s29, 0x18000
    buffer_load_dwordx4 v12, s[20:23], s28 offen lds
    s_waitcnt vmcnt(4)
    s_barrier
    s_add_u32 s3, s69, 3
    s_and_b32 s3, s3, 7
    s_mul_i32 s29, s3, 0x30000
    s_add_u32 m0, s31, 155648
    s_add_u32 s28, s29, 0x0
    buffer_load_dwordx4 v12, s[20:23], s28 offen lds
    s_add_u32 m0, s31, 159744
    s_add_u32 s28, s29, 0x18000
    buffer_load_dwordx4 v12, s[20:23], s28 offen lds
    s_waitcnt vmcnt(4)
    s_barrier
    s_add_u32 s3, s69, 4
    s_and_b32 s3, s3, 7
    s_mul_i32 s29, s3, 0x30000
    s_add_u32 m0, s31, 131072
    s_add_u32 s28, s29, 0x0
    buffer_load_dwordx4 v12, s[20:23], s28 offen lds
    s_add_u32 m0, s31, 135168
    s_add_u32 s28, s29, 0x18000
    buffer_load_dwordx4 v12, s[20:23], s28 offen lds
    s_waitcnt vmcnt(4)
    s_barrier
    s_add_u32 s3, s69, 5
    s_and_b32 s3, s3, 7
    s_mul_i32 s29, s3, 0x30000
    s_add_u32 m0, s31, 139264
    s_add_u32 s28, s29, 0x0
    buffer_load_dwordx4 v12, s[20:23], s28 offen lds
    s_add_u32 m0, s31, 143360
    s_add_u32 s28, s29, 0x18000
    buffer_load_dwordx4 v12, s[20:23], s28 offen lds
    s_waitcnt vmcnt(4)
    s_barrier
    s_add_u32 s3, s69, 6
    s_and_b32 s3, s3, 7
    s_mul_i32 s29, s3, 0x30000
    s_add_u32 m0, s31, 147456
    s_add_u32 s28, s29, 0x0
    buffer_load_dwordx4 v12, s[20:23], s28 offen lds
    s_add_u32 m0, s31, 151552
    s_add_u32 s28, s29, 0x18000
    buffer_load_dwordx4 v12, s[20:23], s28 offen lds
    s_waitcnt vmcnt(4)
    s_barrier
    ds_read_b64 v[46:47], v13 offset:0
    v_and_b32 v13, 31, v0
    v_lshlrev_b32 v13, 3, v13
    s_waitcnt lgkmcnt(0)
    v_readfirstlane_b32 s56, v46
    v_readfirstlane_b32 s57, v47
    s_add_u32 s3, s69, 7
    s_and_b32 s3, s3, 7
    s_mul_i32 s29, s3, 0x30000
    s_add_u32 m0, s31, 155648
    s_add_u32 s28, s29, 0x0
    buffer_load_dwordx4 v12, s[20:23], s28 offen lds
    s_add_u32 m0, s31, 159744
    s_add_u32 s28, s29, 0x18000
    buffer_load_dwordx4 v12, s[20:23], s28 offen lds
    s_waitcnt vmcnt(4)
    s_barrier
    s_waitcnt vmcnt(2)
    s_barrier
    s_waitcnt vmcnt(0)
    s_barrier
    buffer_load_dwordx2 v[224:225], v13, s[24:27], s68 offen offset:0 sc1
    s_mov_b32 s12, s40
    s_mov_b32 s13, s41
    s_mov_b32 s14, 0x80000
    s_mov_b32 s15, 0x00020000
    s_mov_b32 s16, s46
    s_mov_b32 s17, s47
    s_mov_b32 s18, 0x80000
    s_mov_b32 s19, 0x00020000
    s_mov_b32 s20, s50
    s_mov_b32 s21, s51
    s_mov_b32 s22, 0x200000
    s_mov_b32 s23, 0x00020000
    v_mov_b32 v15, 0
    s_mov_b32 exec_lo, 0x110000
    s_mov_b32 exec_hi, 0x110000
    v_mov_b32 v15, 0x3f803f80
    s_mov_b64 exec, -1
    v_mov_b32 v45, 0xdddddddd
    v_mov_b32 v46, s56
    v_mov_b32 v47, s57
    v_mov_b32 v24, v15
    v_mov_b32 v25, v15
    v_mov_b32 v26, v15
    v_mov_b32 v27, v15
    v_mov_b32 v28, v15
    v_mov_b32 v29, v15
    v_mov_b32 v30, v15
    v_mov_b32 v31, v15
    v_mov_b32 v32, v15
    v_mov_b32 v33, v15
    v_mov_b32 v34, v15
    v_mov_b32 v35, v15
    s_lshl_b32 s30, s34, 11
    s_lshl_b32 s28, s35, 16
    s_add_u32 s31, s28, s30
    s_lshl_b32 s29, s64, 13
    s_waitcnt vmcnt(0)
    s_mov_b32 s32, 65536
L_chk1:
    v_cmp_ne_u64 vcc, s[56:57], v[224:225]
    s_nop 0
    s_and_b64 vcc, vcc, s[60:61]
    s_cbranch_scc0 L_ok1
    s_sub_u32 s32, s32, 1
    s_cbranch_scc1 L_ok1
    buffer_load_dwordx2 v[224:225], v13, s[24:27], s68 offen offset:0 sc1
    s_waitcnt vmcnt(0)
    s_branch L_chk1
L_ok1:
    s_add_u32 m0, s30, 0
    s_add_u32 s28, s31, 0x200000
    buffer_load_dwordx4 v1, s[24:27], s28 offen offset:0 sc1 lds
    buffer_load_dwordx4 v1, s[24:27], s28 offen offset:1024 sc1 lds
    s_add_u32 m0, s30, 49152
    s_add_u32 s28, s31, s29
    buffer_load_dwordx4 v1, s[24:27], s28 offen offset:0 sc1 lds
    buffer_load_dwordx4 v1, s[24:27], s28 offen offset:1024 sc1 lds
    s_add_u32 m0, s30, 65536
    s_add_u32 s28, s31, 0x400000
    buffer_load_dwordx4 v1, s[24:27], s28 offen offset:0 sc1 lds
    buffer_load_dwordx4 v1, s[24:27], s28 offen offset:1024 sc1 lds
    s_add_u32 m0, s30, 8192
    s_add_u32 s28, s31, 0x202000
    buffer_load_dwordx4 v1, s[24:27], s28 offen offset:0 sc1 lds
    buffer_load_dwordx4 v1, s[24:27], s28 offen offset:1024 sc1 lds
    s_add_u32 m0, s30, 73728
    s_add_u32 s28, s31, 0x402000
    buffer_load_dwordx4 v1, s[24:27], s28 offen offset:0 sc1 lds
    buffer_load_dwordx4 v1, s[24:27], s28 offen offset:1024 sc1 lds
    s_waitcnt vmcnt(4)
    s_branch L_attn
L_mm:
    s_and_b32 s28, s2, 7
    s_lshl_b32 s28, s28, 2
    s_bfe_u32 s29, s2, 0x20003
    s_add_u32 s28, s28, s29
    s_andn2_b32 s29, s2, 31
    s_add_u32 s28, s28, s29
    s_lshl_b32 s28, s28, 2
    s_add_u32 s28, s28, s34
    s_lshl_b32 s28, s28, 1
    v_and_b32 v20, 31, v0
    v_lshrrev_b32 v21, 5, v0
    v_lshlrev_b32 v209, 5, v20
    v_add_u32 v210, s28, v21
    v_lshl_add_u32 v208, v210, 10, v209
    s_waitcnt lgkmcnt(0)
    s_mov_b32 s8, s36
    s_mov_b32 s9, s37
    s_mov_b32 s10, 0x200000
    s_mov_b32 s11, 0x00020000
    buffer_load_dwordx4 v[212:215], v208, s[8:11], 0 offen
    buffer_load_dwordx4 v[216:219], v208, s[8:11], 0 offen offset:16
    s_and_b32 s71, s33, 1
    s_lshr_b32 s72, s33, 1
    v_lshrrev_b32 v16, 1, v20
    v_and_b32 v16, 7, v16
    v_xor_b32 v16, v16, v21
    v_lshlrev_b32 v16, 4, v16
    v_lshl_add_u32 v8, v20, 7, v16
    s_lshl_b32 s28, s71, 13
    v_add_u32 v8, s28, v8
    v_xor_b32 v9, 32, v8
    v_xor_b32 v10, 64, v8
    v_xor_b32 v11, 0x60, v8
    v_bfe_u32 v16, v0, 2, 2
    v_lshlrev_b32 v12, 7, v16
    v_lshl_add_u32 v12, v21, 10, v12
    v_lshrrev_b32 v16, 1, v16
    v_xor_b32 v16, s72, v16
    v_lshl_add_u32 v12, v16, 6, v12
    v_bfe_u32 v16, v0, 4, 1
    v_lshl_add_u32 v12, v16, 5, v12
    v_and_b32 v17, 3, v0
    v_lshl_add_u32 v12, v17, 3, v12
    v_add_u32 v12, 131072, v12
    v_mov_b32 v240, 0x358637bd
    v_mov_b32 v241, 0x358637bd
    v_mov_b32 v242, 0x358637bd
    v_mov_b32 v243, 0x358637bd
    v_mov_b32 v244, 0x358637bd
    v_mov_b32 v245, 0x358637bd
    v_mov_b32 v246, 0x358637bd
    v_mov_b32 v247, 0x358637bd
    v_mov_b32 v248, 0x358637bd
    v_mov_b32 v249, 0x358637bd
    v_mov_b32 v250, 0x358637bd
    v_mov_b32 v251, 0x358637bd
    v_mov_b32 v252, 0x358637bd
    v_mov_b32 v253, 0x358637bd
    v_mov_b32 v254, 0x358637bd
    v_mov_b32 v255, 0x358637bd
    s_cmp_eq_u32 s76, 1
    s_cbranch_scc1 L_mm_y
    s_waitcnt lgkmcnt(0)
    s_barrier
    ds_read_b128 v[16:19], v8 offset:0
    ds_read_b64_tr_b16 v[24:25], v12 offset:0
    ds_read_b64_tr_b16 v[26:27], v12 offset:512
    ds_read_b128 v[20:23], v8 offset:4096
    ds_read_b64_tr_b16 v[28:29], v12 offset:4096
    ds_read_b64_tr_b16 v[30:31], v12 offset:4608
    ds_read_b128 v[32:35], v9 offset:0
    ds_read_b64_tr_b16 v[40:41], v12 offset:2048
    ds_read_b64_tr_b16 v[42:43], v12 offset:2560
    ds_read_b128 v[36:39], v9 offset:4096
    ds_read_b64_tr_b16 v[44:45], v12 offset:6144
    ds_read_b64_tr_b16 v[46:47], v12 offset:6656
    s_waitcnt lgkmcnt(0)
    s_barrier
    v_mfma_f32_32x32x16_bf16 v[112:127], v[24:27], v[16:19], 0
    ds_read_b128 v[64:67], v10 offset:0
    ds_read_b64_tr_b16 v[72:73], v12 offset:8192
    ds_read_b64_tr_b16 v[74:75], v12 offset:8704
    ds_read_b128 v[68:71], v10 offset:4096
    ds_read_b64_tr_b16 v[76:77], v12 offset:12288
    ds_read_b64_tr_b16 v[78:79], v12 offset:12800
    ds_read_b128 v[80:83], v11 offset:0
    ds_read_b64_tr_b16 v[88:89], v12 offset:10240
    v_mfma_f32_32x32x16_bf16 v[128:143], v[24:27], v[20:23], 0
    ds_read_b64_tr_b16 v[90:91], v12 offset:10752
    ds_read_b128 v[84:87], v11 offset:4096
    ds_read_b64_tr_b16 v[92:93], v12 offset:14336
    ds_read_b64_tr_b16 v[94:95], v12 offset:14848
    s_mov_b32 s16, s48
    s_mov_b32 s17, s49
    s_mov_b32 s18, 0x400
    s_mov_b32 s19, 0x00020000
    buffer_load_dwordx4 v[220:223], v209, s[16:19], 0 offen
    buffer_load_dwordx4 v[224:227], v209, s[16:19], 0 offen offset:16
    v_lshlrev_b32 v230, 7, v0
    v_mfma_f32_32x32x16_bf16 v[144:159], v[16:19], v[28:31], v[240:255]
    v_mfma_f32_32x32x16_bf16 v[160:175], v[20:23], v[28:31], v[240:255]
    v_mfma_f32_32x32x16_bf16 v[112:127], v[40:43], v[32:35], v[112:127]
    v_mfma_f32_32x32x16_bf16 v[128:143], v[40:43], v[36:39], v[128:143]
    v_mfma_f32_32x32x16_bf16 v[144:159], v[32:35], v[44:47], v[144:159]
    v_mfma_f32_32x32x16_bf16 v[160:175], v[36:39], v[44:47], v[160:175]
    s_waitcnt lgkmcnt(0)
    s_barrier
    v_mfma_f32_32x32x16_bf16 v[112:127], v[72:75], v[64:67], v[112:127]
    ds_read_b128 v[16:19], v8 offset:16384
    ds_read_b64_tr_b16 v[24:25], v12 offset:16384
    ds_read_b64_tr_b16 v[26:27], v12 offset:16896
    ds_read_b128 v[20:23], v8 offset:20480
    ds_read_b64_tr_b16 v[28:29], v12 offset:20480
    ds_read_b64_tr_b16 v[30:31], v12 offset:20992
    ds_read_b128 v[32:35], v9 offset:16384
    ds_read_b64_tr_b16 v[40:41], v12 offset:18432
    v_mfma_f32_32x32x16_bf16 v[128:143], v[72:75], v[68:71], v[128:143]
    ds_read_b64_tr_b16 v[42:43], v12 offset:18944
    ds_read_b128 v[36:39], v9 offset:20480
    ds_read_b64_tr_b16 v[44:45], v12 offset:22528
    ds_read_b64_tr_b16 v[46:47], v12 offset:23040
    s_mov_b32 s24, s54
    s_mov_b32 s25, s55
    s_mov_b32 s26, 0x1000000
    s_mov_b32 s27, 0x00020000
    v_mfma_f32_32x32x16_bf16 v[144:159], v[64:67], v[76:79], v[144:159]
    s_mov_b32 s4, s52
    s_mov_b32 s5, s53
    s_mov_b32 s6, 0x100
    s_mov_b32 s7, 0x00020000
    v_lshlrev_b32 v210, 2, v210
    s_mov_b32 s12, s40
    s_mov_b32 s13, s41
    s_mov_b32 s14, 0x80000
    v_mfma_f32_32x32x16_bf16 v[160:175], v[68:71], v[76:79], v[160:175]
    s_mov_b32 s15, 0x00020000
    s_mov_b32 s16, s46
    s_mov_b32 s17, s47
    s_mov_b32 s18, 0x80000
    s_mov_b32 s19, 0x00020000
    s_mov_b32 s20, s50
    s_mov_b32 s21, s51
    s_mov_b32 s22, 0x200000
    v_mfma_f32_32x32x16_bf16 v[112:127], v[88:91], v[80:83], v[112:127]
    s_mov_b32 s23, 0x00020000
    s_and_b32 s28, s2, 7
    s_lshl_b32 s35, s28, 2
    v_mfma_f32_32x32x16_bf16 v[128:143], v[88:91], v[84:87], v[128:143]
    v_mfma_f32_32x32x16_bf16 v[144:159], v[80:83], v[92:95], v[144:159]
    v_mfma_f32_32x32x16_bf16 v[160:175], v[84:87], v[92:95], v[160:175]
    s_waitcnt lgkmcnt(0)
    s_barrier
    v_mfma_f32_32x32x16_bf16 v[112:127], v[24:27], v[16:19], v[112:127]
    ds_read_b128 v[64:67], v10 offset:16384
    ds_read_b64_tr_b16 v[72:73], v12 offset:24576
    ds_read_b64_tr_b16 v[74:75], v12 offset:25088
    ds_read_b128 v[68:71], v10 offset:20480
    ds_read_b64_tr_b16 v[76:77], v12 offset:28672
    ds_read_b64_tr_b16 v[78:79], v12 offset:29184
    ds_read_b128 v[80:83], v11 offset:16384
    ds_read_b64_tr_b16 v[88:89], v12 offset:26624
    v_mfma_f32_32x32x16_bf16 v[128:143], v[24:27], v[20:23], v[128:143]
    ds_read_b64_tr_b16 v[90:91], v12 offset:27136
    ds_read_b128 v[84:87], v11 offset:20480
    ds_read_b64_tr_b16 v[92:93], v12 offset:30720
    ds_read_b64_tr_b16 v[94:95], v12 offset:31232
    s_bfe_u32 s28, s2, 0x20003
    s_add_u32 s35, s35, s28
    s_lshr_b32 s64, s2, 5
    s_lshl_b32 s68, s2, 11
    v_mfma_f32_32x32x16_bf16 v[144:159], v[16:19], v[28:31], v[144:159]
    s_add_u32 s68, s68, 0xa40000
    s_lshl_b32 s65, s64, 3
    s_add_u32 s65, s65, s33
    v_and_b32 v4, 15, v0
    v_lshlrev_b32 v4, 4, v4
    v_lshrrev_b32 v232, 5, v0
    v_lshl_add_u32 v4, v232, 8, v4
    v_add_u32 v4, 0x10000, v4
    v_mfma_f32_32x32x16_bf16 v[160:175], v[20:23], v[28:31], v[160:175]
    v_lshrrev_b32 v233, 3, v0
    v_bfe_u32 v234, v0, 4, 1
    v_lshlrev_b32 v235, 2, v234
    v_and_b32 v5, 7, v0
    v_xor_b32 v5, v5, v235
    v_lshlrev_b32 v5, 4, v5
    v_lshl_add_u32 v5, v233, 10, v5
    v_bfe_u32 v233, v0, 2, 2
    v_mfma_f32_32x32x16_bf16 v[112:127], v[40:43], v[32:35], v[112:127]
    v_lshlrev_b32 v6, 7, v233
    v_lshl_add_u32 v6, v232, 9, v6
    v_lshrrev_b32 v233, 1, v233
    v_mfma_f32_32x32x16_bf16 v[128:143], v[40:43], v[36:39], v[128:143]
    v_mfma_f32_32x32x16_bf16 v[144:159], v[32:35], v[44:47], v[144:159]
    v_mfma_f32_32x32x16_bf16 v[160:175], v[36:39], v[44:47], v[160:175]
    s_waitcnt lgkmcnt(0)
    s_barrier
    v_mfma_f32_32x32x16_bf16 v[112:127], v[72:75], v[64:67], v[112:127]
    ds_read_b128 v[16:19], v8 offset:32768
    ds_read_b64_tr_b16 v[24:25], v12 offset:0
    ds_read_b64_tr_b16 v[26:27], v12 offset:512
    ds_read_b128 v[20:23], v8 offset:36864
    ds_read_b64_tr_b16 v[28:29], v12 offset:4096
    ds_read_b64_tr_b16 v[30:31], v12 offset:4608
    ds_read_b128 v[32:35], v9 offset:32768
    ds_read_b64_tr_b16 v[40:41], v12 offset:2048
    v_mfma_f32_32x32x16_bf16 v[128:143], v[72:75], v[68:71], v[128:143]
    ds_read_b64_tr_b16 v[42:43], v12 offset:2560
    ds_read_b128 v[36:39], v9 offset:36864
    ds_read_b64_tr_b16 v[44:45], v12 offset:6144
    ds_read_b64_tr_b16 v[46:47], v12 offset:6656
    v_lshl_add_u32 v6, v233, 6, v6
    v_lshl_add_u32 v6, v234, 5, v6
    v_and_b32 v233, 1, v0
    v_lshl_add_u32 v6, v233, 4, v6
    v_mfma_f32_32x32x16_bf16 v[144:159], v[64:67], v[76:79], v[144:159]
    v_bfe_u32 v234, v0, 1, 1
    v_lshl_add_u32 v6, v234, 3, v6
    v_and_b32 v233, 7, v0
    v_lshlrev_b32 v14, 14, v233
    s_lshl_b32 s70, s33, 10
    s_and_b32 s71, s33, 1
    s_lshr_b32 s72, s33, 1
    s_bfe_u32 s73, s2, 0x30003
    v_mfma_f32_32x32x16_bf16 v[160:175], v[68:71], v[76:79], v[160:175]
    s_lshl_b32 s28, s35, 16
    s_add_u32 s78, s28, s70
    s_lshl_b32 s29, s65, 10
    s_add_u32 s79, s28, s29
    s_add_u32 s79, s79, 0x600000
    s_lshl_b32 s29, s72, 13
    s_add_u32 s42, s28, s29
    s_lshl_b32 s29, s71, 10
    v_mfma_f32_32x32x16_bf16 v[112:127], v[88:91], v[80:83], v[112:127]
    s_add_u32 s42, s42, s29
    s_add_u32 s42, s42, 0x800000
    s_lshl_b32 s28, s65, 16
    v_mfma_f32_32x32x16_bf16 v[128:143], v[88:91], v[84:87], v[128:143]
    v_mfma_f32_32x32x16_bf16 v[144:159], v[80:83], v[92:95], v[144:159]
    v_mfma_f32_32x32x16_bf16 v[160:175], v[84:87], v[92:95], v[160:175]
    s_waitcnt lgkmcnt(0)
    s_barrier
    v_mfma_f32_32x32x16_bf16 v[112:127], v[24:27], v[16:19], v[112:127]
    ds_read_b128 v[64:67], v10 offset:32768
    ds_read_b64_tr_b16 v[72:73], v12 offset:8192
    ds_read_b64_tr_b16 v[74:75], v12 offset:8704
    ds_read_b128 v[68:71], v10 offset:36864
    ds_read_b64_tr_b16 v[76:77], v12 offset:12288
    ds_read_b64_tr_b16 v[78:79], v12 offset:12800
    ds_read_b128 v[80:83], v11 offset:32768
    ds_read_b64_tr_b16 v[88:89], v12 offset:10240
    v_mfma_f32_32x32x16_bf16 v[128:143], v[24:27], v[20:23], v[128:143]
    ds_read_b64_tr_b16 v[90:91], v12 offset:10752
    ds_read_b128 v[84:87], v11 offset:36864
    ds_read_b64_tr_b16 v[92:93], v12 offset:14336
    ds_read_b64_tr_b16 v[94:95], v12 offset:14848
    s_waitcnt vmcnt(0)
    v_dot2_f32_bf16 v211, v212, v220, 0
    v_dot2_f32_bf16 v211, v213, v221, v211
    v_dot2_f32_bf16 v211, v214, v222, v211
    v_dot2_f32_bf16 v211, v215, v223, v211
    v_mfma_f32_32x32x16_bf16 v[144:159], v[16:19], v[28:31], v[144:159]
    v_dot2_f32_bf16 v211, v216, v224, v211
    v_dot2_f32_bf16 v211, v217, v225, v211
    v_dot2_f32_bf16 v211, v218, v226, v211
    v_dot2_f32_bf16 v211, v219, v227, v211
    v_mfma_f32_32x32x16_bf16 v[160:175], v[20:23], v[28:31], v[160:175]
    v_mfma_f32_32x32x16_bf16 v[112:127], v[40:43], v[32:35], v[112:127]
    v_mfma_f32_32x32x16_bf16 v[128:143], v[40:43], v[36:39], v[128:143]
    v_mfma_f32_32x32x16_bf16 v[144:159], v[32:35], v[44:47], v[144:159]
    v_mfma_f32_32x32x16_bf16 v[160:175], v[36:39], v[44:47], v[160:175]
    s_waitcnt lgkmcnt(0)
    s_barrier
    v_mfma_f32_32x32x16_bf16 v[112:127], v[72:75], v[64:67], v[112:127]
    ds_read_b128 v[16:19], v8 offset:49152
    ds_read_b64_tr_b16 v[24:25], v12 offset:16384
    ds_read_b64_tr_b16 v[26:27], v12 offset:16896
    ds_read_b128 v[20:23], v8 offset:53248
    ds_read_b64_tr_b16 v[28:29], v12 offset:20480
    ds_read_b64_tr_b16 v[30:31], v12 offset:20992
    ds_read_b128 v[32:35], v9 offset:49152
    ds_read_b64_tr_b16 v[40:41], v12 offset:18432
    v_mfma_f32_32x32x16_bf16 v[128:143], v[72:75], v[68:71], v[128:143]
    ds_read_b64_tr_b16 v[42:43], v12 offset:18944
    ds_read_b128 v[36:39], v9 offset:53248
    ds_read_b64_tr_b16 v[44:45], v12 offset:22528
    ds_read_b64_tr_b16 v[46:47], v12 offset:23040
    v_add_f32_dpp v211, v211, v211 row_ror:8 row_mask:0xf bank_mask:0xf
    s_nop 1
    v_add_f32_dpp v211, v211, v211 row_ror:4 row_mask:0xf bank_mask:0xf
    s_nop 1
    v_add_f32_dpp v211, v211, v211 row_ror:2 row_mask:0xf bank_mask:0xf
    s_nop 1
    v_add_f32_dpp v211, v211, v211 row_ror:1 row_mask:0xf bank_mask:0xf
    v_mfma_f32_32x32x16_bf16 v[144:159], v[64:67], v[76:79], v[144:159]
    v_mov_b32 v212, v211
    s_nop 1
    v_permlane16_swap_b32 v211, v212
    v_add_f32 v211, v211, v212
    v_mfma_f32_32x32x16_bf16 v[160:175], v[68:71], v[76:79], v[160:175]
    v_mfma_f32_32x32x16_bf16 v[112:127], v[88:91], v[80:83], v[112:127]
    v_mfma_f32_32x32x16_bf16 v[128:143], v[88:91], v[84:87], v[128:143]
    v_mfma_f32_32x32x16_bf16 v[144:159], v[80:83], v[92:95], v[144:159]
    v_mfma_f32_32x32x16_bf16 v[160:175], v[84:87], v[92:95], v[160:175]
    s_waitcnt lgkmcnt(0)
    s_barrier
    v_mfma_f32_32x32x16_bf16 v[112:127], v[24:27], v[16:19], v[112:127]
    ds_read_b128 v[64:67], v10 offset:49152
    ds_read_b64_tr_b16 v[72:73], v12 offset:24576
    ds_read_b64_tr_b16 v[74:75], v12 offset:25088
    ds_read_b128 v[68:71], v10 offset:53248
    ds_read_b64_tr_b16 v[76:77], v12 offset:28672
    ds_read_b64_tr_b16 v[78:79], v12 offset:29184
    ds_read_b128 v[80:83], v11 offset:49152
    ds_read_b64_tr_b16 v[88:89], v12 offset:26624
    v_mfma_f32_32x32x16_bf16 v[128:143], v[24:27], v[20:23], v[128:143]
    ds_read_b64_tr_b16 v[90:91], v12 offset:27136
    ds_read_b128 v[84:87], v11 offset:53248
    ds_read_b64_tr_b16 v[92:93], v12 offset:30720
    ds_read_b64_tr_b16 v[94:95], v12 offset:31232
    v_mul_f32 v211, 0xbfb8aa3b, v211
    v_exp_f32 v211, v211
    s_nop 0
    v_add_f32 v211, 1.0, v211
    v_rcp_f32 v211, v211
    v_mfma_f32_32x32x16_bf16 v[144:159], v[16:19], v[28:31], v[144:159]
    s_mov_b32 s3, 0xa00000
    s_mov_b32 exec_lo, 1
    s_mov_b32 exec_hi, 1
    buffer_store_dword v211, v210, s[24:27], s3 offen sc1
    s_mov_b64 exec, -1
    v_mfma_f32_32x32x16_bf16 v[160:175], v[20:23], v[28:31], v[160:175]
    v_mfma_f32_32x32x16_bf16 v[112:127], v[40:43], v[32:35], v[112:127]
    v_mfma_f32_32x32x16_bf16 v[128:143], v[40:43], v[36:39], v[128:143]
    v_mfma_f32_32x32x16_bf16 v[144:159], v[32:35], v[44:47], v[144:159]
    v_mfma_f32_32x32x16_bf16 v[160:175], v[36:39], v[44:47], v[160:175]
    s_waitcnt lgkmcnt(0)
    s_barrier
    v_mfma_f32_32x32x16_bf16 v[112:127], v[72:75], v[64:67], v[112:127]
    v_add_u32 v8, 0x10000, v8
    v_add_u32 v9, 0x10000, v9
    v_add_u32 v10, 0x10000, v10
    v_add_u32 v11, 0x10000, v11
    ds_read_b128 v[16:19], v8 offset:0
    ds_read_b64_tr_b16 v[24:25], v12 offset:0
    ds_read_b64_tr_b16 v[26:27], v12 offset:512
    ds_read_b128 v[20:23], v8 offset:4096
    ds_read_b64_tr_b16 v[28:29], v12 offset:4096
    ds_read_b64_tr_b16 v[30:31], v12 offset:4608
    ds_read_b128 v[32:35], v9 offset:0
    v_mfma_f32_32x32x16_bf16 v[128:143], v[72:75], v[68:71], v[128:143]
    ds_read_b64_tr_b16 v[40:41], v12 offset:2048
    ds_read_b64_tr_b16 v[42:43], v12 offset:2560
    ds_read_b128 v[36:39], v9 offset:4096
    ds_read_b64_tr_b16 v[44:45], v12 offset:6144
    ds_read_b64_tr_b16 v[46:47], v12 offset:6656
    s_lshl_b32 s29, s35, 10
    s_add_u32 s43, s28, s29
    s_add_u32 s43, s43, 0xb00000
    v_mfma_f32_32x32x16_bf16 v[144:159], v[64:67], v[76:79], v[144:159]
    s_lshl_b32 s49, s65, 7
    s_add_u32 s49, s49, 0xa00000
    s_lshl_b32 s28, s33, 16
    s_lshl_b32 s29, s73, 7
    s_add_u32 s37, s28, s29
    s_lshl_b32 s48, s33, 13
    s_and_b32 s28, s48, 0x8000
    s_add_u32 s48, s48, s28
    v_mfma_f32_32x32x16_bf16 v[160:175], v[68:71], v[76:79], v[160:175]
    s_andn2_b32 s28, s48, 0x2000
    v_add_u32 v6, s28, v6
    s_cmp_eq_u32 s72, 1
    s_cselect_b32 s53, 5, 4
    s_cmp_eq_u32 s72, 0
    s_cselect_b32 s53, 2, s53
    s_lshl_b32 s53, s53, 14
    v_xor_b32 v7, 64, v6
    v_mfma_f32_32x32x16_bf16 v[112:127], v[88:91], v[80:83], v[112:127]
    s_lshr_b32 s28, s2, 6
    s_lshl_b32 s28, s28, 1
    s_add_u32 s28, s28, s71
    s_and_b32 s29, s2, 7
    v_mfma_f32_32x32x16_bf16 v[128:143], v[88:91], v[84:87], v[128:143]
    v_mfma_f32_32x32x16_bf16 v[144:159], v[80:83], v[92:95], v[144:159]
    v_mfma_f32_32x32x16_bf16 v[160:175], v[84:87], v[92:95], v[160:175]
    s_waitcnt lgkmcnt(0)
    s_barrier
    v_mfma_f32_32x32x16_bf16 v[112:127], v[24:27], v[16:19], v[112:127]
    ds_read_b128 v[64:67], v10 offset:0
    ds_read_b64_tr_b16 v[72:73], v12 offset:8192
    ds_read_b64_tr_b16 v[74:75], v12 offset:8704
    ds_read_b128 v[68:71], v10 offset:4096
    ds_read_b64_tr_b16 v[76:77], v12 offset:12288
    ds_read_b64_tr_b16 v[78:79], v12 offset:12800
    ds_read_b128 v[80:83], v11 offset:0
    ds_read_b64_tr_b16 v[88:89], v12 offset:10240
    v_mfma_f32_32x32x16_bf16 v[128:143], v[24:27], v[20:23], v[128:143]
    ds_read_b64_tr_b16 v[90:91], v12 offset:10752
    ds_read_b128 v[84:87], v11 offset:4096
    ds_read_b64_tr_b16 v[92:93], v12 offset:14336
    ds_read_b64_tr_b16 v[94:95], v12 offset:14848
    s_lshl_b32 s29, s29, 3
    s_add_u32 s74, s28, s29
    s_lshl_b32 s28, s74, 16
    s_lshl_b32 s29, s72, 13
    v_mfma_f32_32x32x16_bf16 v[144:159], v[16:19], v[28:31], v[144:159]
    s_add_u32 s36, s28, s29
    s_add_u32 s36, s36, 0xb00000
    s_lshl_b32 s29, s72, 6
    s_add_u32 s28, s64, s29
    s_lshl_b32 s28, s28, 11
    s_lshl_b32 s29, s71, 5
    s_add_u32 s29, s29, s35
    s_lshl_b32 s29, s29, 3
    v_mfma_f32_32x32x16_bf16 v[160:175], v[20:23], v[28:31], v[160:175]
    s_add_u32 s28, s28, s29
    s_add_u32 s77, s28, 0xa40000
    s_lshl_b32 s28, s71, 8
    s_lshl_b32 s29, s72, 6
    s_add_u32 s28, s28, s29
    s_add_u32 s75, s28, s68
    s_mov_b32 s58, 0xffff
    s_mov_b32 s59, 0xffff
    v_mfma_f32_32x32x16_bf16 v[112:127], v[40:43], v[32:35], v[112:127]
    v_and_b32 v2, 0x33, v0
    v_bfe_u32 v232, v0, 2, 1
    v_lshl_or_b32 v2, v232, 3, v2
    v_mfma_f32_32x32x16_bf16 v[128:143], v[40:43], v[36:39], v[128:143]
    v_mfma_f32_32x32x16_bf16 v[144:159], v[32:35], v[44:47], v[144:159]
    v_mfma_f32_32x32x16_bf16 v[160:175], v[36:39], v[44:47], v[160:175]
    s_waitcnt lgkmcnt(0)
    s_barrier
    v_mfma_f32_32x32x16_bf16 v[112:127], v[72:75], v[64:67], v[112:127]
    ds_read_b128 v[16:19], v8 offset:16384
    ds_read_b64_tr_b16 v[24:25], v12 offset:16384
    ds_read_b64_tr_b16 v[26:27], v12 offset:16896
    ds_read_b128 v[20:23], v8 offset:20480
    ds_read_b64_tr_b16 v[28:29], v12 offset:20480
    ds_read_b64_tr_b16 v[30:31], v12 offset:20992
    ds_read_b128 v[32:35], v9 offset:16384
    ds_read_b64_tr_b16 v[40:41], v12 offset:18432
    v_mfma_f32_32x32x16_bf16 v[128:143], v[72:75], v[68:71], v[128:143]
    ds_read_b64_tr_b16 v[42:43], v12 offset:18944
    ds_read_b128 v[36:39], v9 offset:20480
    ds_read_b64_tr_b16 v[44:45], v12 offset:22528
    ds_read_b64_tr_b16 v[46:47], v12 offset:23040
    v_bfe_u32 v232, v0, 3, 1
    v_lshl_or_b32 v2, v232, 2, v2
    v_lshlrev_b32 v2, 4, v2
    v_bfe_u32 v232, v0, 4, 1
    v_mfma_f32_32x32x16_bf16 v[144:159], v[64:67], v[76:79], v[144:159]
    v_lshl_add_u32 v3, v232, 16, v4
    v_mov_b32 v13, 0
    s_lshl_b32 s28, s66, 1
    s_add_u32 s28, s28, s72
    s_lshl_b32 s29, s28, 17
    s_lshl_b32 s28, s67, 11
    s_add_u32 s55, s29, s28
    s_xor_b32 s55, s55, 1048576
    v_mfma_f32_32x32x16_bf16 v[160:175], v[68:71], v[76:79], v[160:175]
    s_lshl_b32 s28, s67, 1
    s_add_u32 s28, s28, s71
    s_lshl_b32 s28, s28, 11
    s_add_u32 s52, s29, s28
    s_mov_b32 s62, 0x3eb8aa3b
    s_mov_b32 s63, 0x3eb8aa3b
    s_xor_b32 s54, s71, 1
    s_lshl_b32 s54, s54, 1
    v_mfma_f32_32x32x16_bf16 v[112:127], v[88:91], v[80:83], v[112:127]
    v_mfma_f32_32x32x16_bf16 v[128:143], v[88:91], v[84:87], v[128:143]
    v_mfma_f32_32x32x16_bf16 v[144:159], v[80:83], v[92:95], v[144:159]
    v_mfma_f32_32x32x16_bf16 v[160:175], v[84:87], v[92:95], v[160:175]
    s_waitcnt lgkmcnt(0)
    s_barrier
    v_mfma_f32_32x32x16_bf16 v[112:127], v[24:27], v[16:19], v[112:127]
    ds_read_b128 v[64:67], v10 offset:16384
    ds_read_b64_tr_b16 v[72:73], v12 offset:24576
    ds_read_b64_tr_b16 v[74:75], v12 offset:25088
    ds_read_b128 v[68:71], v10 offset:20480
    ds_read_b64_tr_b16 v[76:77], v12 offset:28672
    ds_read_b64_tr_b16 v[78:79], v12 offset:29184
    ds_read_b128 v[80:83], v11 offset:16384
    ds_read_b64_tr_b16 v[88:89], v12 offset:26624
    v_mfma_f32_32x32x16_bf16 v[128:143], v[24:27], v[20:23], v[128:143]
    ds_read_b64_tr_b16 v[90:91], v12 offset:27136
    ds_read_b128 v[84:87], v11 offset:20480
    ds_read_b64_tr_b16 v[92:93], v12 offset:30720
    ds_read_b64_tr_b16 v[94:95], v12 offset:31232
    v_mfma_f32_32x32x16_bf16 v[144:159], v[16:19], v[28:31], v[144:159]
    v_mfma_f32_32x32x16_bf16 v[160:175], v[20:23], v[28:31], v[160:175]
    v_mfma_f32_32x32x16_bf16 v[112:127], v[40:43], v[32:35], v[112:127]
    v_mfma_f32_32x32x16_bf16 v[128:143], v[40:43], v[36:39], v[128:143]
    v_mfma_f32_32x32x16_bf16 v[144:159], v[32:35], v[44:47], v[144:159]
    v_mfma_f32_32x32x16_bf16 v[160:175], v[36:39], v[44:47], v[160:175]
    s_waitcnt lgkmcnt(0)
    s_barrier
    v_mfma_f32_32x32x16_bf16 v[112:127], v[72:75], v[64:67], v[112:127]
    ds_read_b128 v[16:19], v8 offset:32768
    ds_read_b64_tr_b16 v[24:25], v12 offset:0
    ds_read_b64_tr_b16 v[26:27], v12 offset:512
    ds_read_b128 v[20:23], v8 offset:36864
    ds_read_b64_tr_b16 v[28:29], v12 offset:4096
    ds_read_b64_tr_b16 v[30:31], v12 offset:4608
    ds_read_b128 v[32:35], v9 offset:32768
    ds_read_b64_tr_b16 v[40:41], v12 offset:2048
    v_mfma_f32_32x32x16_bf16 v[128:143], v[72:75], v[68:71], v[128:143]
    ds_read_b64_tr_b16 v[42:43], v12 offset:2560
    ds_read_b128 v[36:39], v9 offset:36864
    ds_read_b64_tr_b16 v[44:45], v12 offset:6144
    ds_read_b64_tr_b16 v[46:47], v12 offset:6656
    s_cmp_lg_u32 s33, 0
    s_cbranch_scc1 L_notag_x
    buffer_load_dwordx2 v[240:241], v13, s[4:7], 0 offen sc1
L_notag_x:
    v_mfma_f32_32x32x16_bf16 v[144:159], v[64:67], v[76:79], v[144:159]
    v_mfma_f32_32x32x16_bf16 v[160:175], v[68:71], v[76:79], v[160:175]
    v_mfma_f32_32x32x16_bf16 v[112:127], v[88:91], v[80:83], v[112:127]
    v_mfma_f32_32x32x16_bf16 v[128:143], v[88:91], v[84:87], v[128:143]
    v_mfma_f32_32x32x16_bf16 v[144:159], v[80:83], v[92:95], v[144:159]
    v_mfma_f32_32x32x16_bf16 v[160:175], v[84:87], v[92:95], v[160:175]
    s_waitcnt lgkmcnt(0)
    s_barrier
    v_mfma_f32_32x32x16_bf16 v[112:127], v[24:27], v[16:19], v[112:127]
    ds_read_b128 v[64:67], v10 offset:32768
    ds_read_b64_tr_b16 v[72:73], v12 offset:8192
    ds_read_b64_tr_b16 v[74:75], v12 offset:8704
    ds_read_b128 v[68:71], v10 offset:36864
    ds_read_b64_tr_b16 v[76:77], v12 offset:12288
    ds_read_b64_tr_b16 v[78:79], v12 offset:12800
    ds_read_b128 v[80:83], v11 offset:32768
    ds_read_b64_tr_b16 v[88:89], v12 offset:10240
    v_mfma_f32_32x32x16_bf16 v[128:143], v[24:27], v[20:23], v[128:143]
    ds_read_b64_tr_b16 v[90:91], v12 offset:10752
    ds_read_b128 v[84:87], v11 offset:36864
    ds_read_b64_tr_b16 v[92:93], v12 offset:14336
    ds_read_b64_tr_b16 v[94:95], v12 offset:14848
    v_mfma_f32_32x32x16_bf16 v[144:159], v[16:19], v[28:31], v[144:159]
    v_mfma_f32_32x32x16_bf16 v[160:175], v[20:23], v[28:31], v[160:175]
    v_mfma_f32_32x32x16_bf16 v[112:127], v[40:43], v[32:35], v[112:127]
    v_mfma_f32_32x32x16_bf16 v[128:143], v[40:43], v[36:39], v[128:143]
    v_mfma_f32_32x32x16_bf16 v[144:159], v[32:35], v[44:47], v[144:159]
    v_mfma_f32_32x32x16_bf16 v[160:175], v[36:39], v[44:47], v[160:175]
    s_waitcnt lgkmcnt(0)
    s_barrier
    v_mfma_f32_32x32x16_bf16 v[112:127], v[72:75], v[64:67], v[112:127]
    ds_read_b128 v[16:19], v8 offset:49152
    ds_read_b64_tr_b16 v[24:25], v12 offset:16384
    ds_read_b64_tr_b16 v[26:27], v12 offset:16896
    ds_read_b128 v[20:23], v8 offset:53248
    ds_read_b64_tr_b16 v[28:29], v12 offset:20480
    ds_read_b64_tr_b16 v[30:31], v12 offset:20992
    ds_read_b128 v[32:35], v9 offset:49152
    ds_read_b64_tr_b16 v[40:41], v12 offset:18432
    v_mfma_f32_32x32x16_bf16 v[128:143], v[72:75], v[68:71], v[128:143]
    ds_read_b64_tr_b16 v[42:43], v12 offset:18944
    ds_read_b128 v[36:39], v9 offset:53248
    ds_read_b64_tr_b16 v[44:45], v12 offset:22528
    ds_read_b64_tr_b16 v[46:47], v12 offset:23040
    v_mfma_f32_32x32x16_bf16 v[144:159], v[64:67], v[76:79], v[144:159]
    v_mfma_f32_32x32x16_bf16 v[160:175], v[68:71], v[76:79], v[160:175]
    v_mfma_f32_32x32x16_bf16 v[112:127], v[88:91], v[80:83], v[112:127]
    v_mfma_f32_32x32x16_bf16 v[128:143], v[88:91], v[84:87], v[128:143]
    v_mfma_f32_32x32x16_bf16 v[144:159], v[80:83], v[92:95], v[144:159]
    v_mfma_f32_32x32x16_bf16 v[160:175], v[84:87], v[92:95], v[160:175]
    s_waitcnt lgkmcnt(0)
    s_barrier
    v_mfma_f32_32x32x16_bf16 v[112:127], v[24:27], v[16:19], v[112:127]
    ds_read_b128 v[64:67], v10 offset:49152
    ds_read_b64_tr_b16 v[72:73], v12 offset:24576
    ds_read_b64_tr_b16 v[74:75], v12 offset:25088
    ds_read_b128 v[68:71], v10 offset:53248
    ds_read_b64_tr_b16 v[76:77], v12 offset:28672
    ds_read_b64_tr_b16 v[78:79], v12 offset:29184
    ds_read_b128 v[80:83], v11 offset:49152
    ds_read_b64_tr_b16 v[88:89], v12 offset:26624
    v_mfma_f32_32x32x16_bf16 v[128:143], v[24:27], v[20:23], v[128:143]
    ds_read_b64_tr_b16 v[90:91], v12 offset:27136
    ds_read_b128 v[84:87], v11 offset:53248
    ds_read_b64_tr_b16 v[92:93], v12 offset:30720
    ds_read_b64_tr_b16 v[94:95], v12 offset:31232
    v_mfma_f32_32x32x16_bf16 v[144:159], v[16:19], v[28:31], v[144:159]
    v_mfma_f32_32x32x16_bf16 v[160:175], v[20:23], v[28:31], v[160:175]
    v_mfma_f32_32x32x16_bf16 v[112:127], v[40:43], v[32:35], v[112:127]
    v_mfma_f32_32x32x16_bf16 v[128:143], v[40:43], v[36:39], v[128:143]
    v_mfma_f32_32x32x16_bf16 v[144:159], v[32:35], v[44:47], v[144:159]
    v_mfma_f32_32x32x16_bf16 v[160:175], v[36:39], v[44:47], v[160:175]
    s_waitcnt lgkmcnt(0)
    s_barrier
    v_mfma_f32_32x32x16_bf16 v[112:127], v[72:75], v[64:67], v[112:127]
    v_subrev_u32 v8, 0x10000, v8
    v_subrev_u32 v9, 0x10000, v9
    v_subrev_u32 v10, 0x10000, v10
    v_subrev_u32 v11, 0x10000, v11
    ds_read_b64_tr_b16 v[24:25], v12 offset:0
    ds_read_b64_tr_b16 v[26:27], v12 offset:512
    ds_read_b128 v[16:19], v8 offset:0
    ds_read_b128 v[20:23], v8 offset:4096
    ds_read_b64_tr_b16 v[36:37], v12 offset:2048
    ds_read_b64_tr_b16 v[38:39], v12 offset:2560
    ds_read_b128 v[28:31], v9 offset:0
    v_mfma_f32_32x32x16_bf16 v[128:143], v[72:75], v[68:71], v[128:143]
    ds_read_b128 v[32:35], v9 offset:4096
    ds_read_b64_tr_b16 v[48:49], v12 offset:4096
    ds_read_b64_tr_b16 v[50:51], v12 offset:4608
    ds_read_b128 v[40:43], v10 offset:0
    ds_read_b128 v[44:47], v10 offset:4096
    s_waitcnt lgkmcnt(8)
    ds_read_b64_tr_b16 v[60:61], v12 offset:6144
    ds_read_b64_tr_b16 v[62:63], v12 offset:6656
    v_mfma_f32_32x32x16_bf16 v[144:159], v[64:67], v[76:79], v[144:159]
    ds_read_b128 v[52:55], v11 offset:0
    ds_read_b128 v[56:59], v11 offset:4096
    v_mfma_f32_32x32x16_bf16 v[160:175], v[68:71], v[76:79], v[160:175]
    v_mfma_f32_32x32x16_bf16 v[112:127], v[88:91], v[80:83], v[112:127]
    v_mfma_f32_32x32x16_bf16 v[128:143], v[88:91], v[84:87], v[128:143]
    v_mfma_f32_32x32x16_bf16 v[144:159], v[80:83], v[92:95], v[144:159]
    v_mfma_f32_32x32x16_bf16 v[160:175], v[84:87], v[92:95], v[160:175]
    s_nop 8
    v_pk_mul_f32 v[112:113], v[112:113], s[62:63]
    v_pk_mul_f32 v[114:115], v[114:115], s[62:63]
    v_pk_mul_f32 v[116:117], v[116:117], s[62:63]
    v_pk_mul_f32 v[118:119], v[118:119], s[62:63]
    v_cvt_pk_bf16_f32 v208, v112, v113
    v_cvt_pk_bf16_f32 v209, v114, v115
    v_cvt_pk_bf16_f32 v210, v116, v117
    v_cvt_pk_bf16_f32 v211, v118, v119
    s_add_u32 s28, s52, 0x0
    buffer_store_dwordx4 v[208:211], v1, s[24:27], s28 offen offset:0 sc1
    v_pk_mul_f32 v[120:121], v[120:121], s[62:63]
    v_pk_mul_f32 v[122:123], v[122:123], s[62:63]
    v_pk_mul_f32 v[124:125], v[124:125], s[62:63]
    v_pk_mul_f32 v[126:127], v[126:127], s[62:63]
    v_cvt_pk_bf16_f32 v212, v120, v121
    v_cvt_pk_bf16_f32 v213, v122, v123
    v_cvt_pk_bf16_f32 v214, v124, v125
    v_cvt_pk_bf16_f32 v215, v126, v127
    s_add_u32 s28, s52, 0x10000
    buffer_store_dwordx4 v[212:215], v1, s[24:27], s28 offen offset:0 sc1
    v_pk_mul_f32 v[128:129], v[128:129], s[62:63]
    v_pk_mul_f32 v[130:131], v[130:131], s[62:63]
    v_pk_mul_f32 v[132:133], v[132:133], s[62:63]
    v_pk_mul_f32 v[134:135], v[134:135], s[62:63]
    v_cvt_pk_bf16_f32 v216, v128, v129
    v_cvt_pk_bf16_f32 v217, v130, v131
    v_cvt_pk_bf16_f32 v218, v132, v133
    v_cvt_pk_bf16_f32 v219, v134, v135
    s_add_u32 s28, s52, 0x0
    buffer_store_dwordx4 v[216:219], v1, s[24:27], s28 offen offset:1024 sc1
    v_pk_mul_f32 v[136:137], v[136:137], s[62:63]
    v_pk_mul_f32 v[138:139], v[138:139], s[62:63]
    v_pk_mul_f32 v[140:141], v[140:141], s[62:63]
    v_pk_mul_f32 v[142:143], v[142:143], s[62:63]
    v_cvt_pk_bf16_f32 v220, v136, v137
    v_cvt_pk_bf16_f32 v221, v138, v139
    v_cvt_pk_bf16_f32 v222, v140, v141
    v_cvt_pk_bf16_f32 v223, v142, v143
    s_add_u32 s28, s52, 0x10000
    buffer_store_dwordx4 v[220:223], v1, s[24:27], s28 offen offset:1024 sc1
    s_waitcnt lgkmcnt(0)
    s_barrier
    v_mfma_f32_32x32x16_bf16 v[176:191], v[16:19], v[24:27], 0
    ds_read_b64_tr_b16 v[72:73], v12 offset:8192
    ds_read_b64_tr_b16 v[74:75], v12 offset:8704
    ds_read_b128 v[64:67], v8 offset:16384
    ds_read_b128 v[68:71], v8 offset:20480
    ds_read_b64_tr_b16 v[84:85], v12 offset:10240
    ds_read_b64_tr_b16 v[86:87], v12 offset:10752
    ds_read_b128 v[76:79], v9 offset:16384
    ds_read_b128 v[80:83], v9 offset:20480
    v_mfma_f32_32x32x16_bf16 v[192:207], v[20:23], v[24:27], 0
    ds_read_b64_tr_b16 v[96:97], v12 offset:12288
    ds_read_b64_tr_b16 v[98:99], v12 offset:12800
    ds_read_b128 v[88:91], v10 offset:16384
    ds_read_b128 v[92:95], v10 offset:20480
    s_waitcnt lgkmcnt(8)
    ds_read_b64_tr_b16 v[108:109], v12 offset:14336
    ds_read_b64_tr_b16 v[110:111], v12 offset:14848
    ds_read_b128 v[100:103], v11 offset:16384
    v_mfma_f32_32x32x16_bf16 v[176:191], v[28:31], v[36:39], v[176:191]
    ds_read_b128 v[104:107], v11 offset:20480
    v_mfma_f32_32x32x16_bf16 v[192:207], v[32:35], v[36:39], v[192:207]
    v_mfma_f32_32x32x16_bf16 v[176:191], v[40:43], v[48:51], v[176:191]
    v_mfma_f32_32x32x16_bf16 v[192:207], v[44:47], v[48:51], v[192:207]
    v_mfma_f32_32x32x16_bf16 v[176:191], v[52:55], v[60:63], v[176:191]
    v_mfma_f32_32x32x16_bf16 v[192:207], v[56:59], v[60:63], v[192:207]
    s_waitcnt lgkmcnt(0)
    s_barrier
    v_mfma_f32_32x32x16_bf16 v[176:191], v[64:67], v[72:75], v[176:191]
    ds_read_b64_tr_b16 v[24:25], v12 offset:16384
    ds_read_b64_tr_b16 v[26:27], v12 offset:16896
    ds_read_b128 v[16:19], v8 offset:32768
    ds_read_b128 v[20:23], v8 offset:36864
    ds_read_b64_tr_b16 v[36:37], v12 offset:18432
    ds_read_b64_tr_b16 v[38:39], v12 offset:18944
    ds_read_b128 v[28:31], v9 offset:32768
    ds_read_b128 v[32:35], v9 offset:36864
    v_mfma_f32_32x32x16_bf16 v[192:207], v[68:71], v[72:75], v[192:207]
    ds_read_b64_tr_b16 v[48:49], v12 offset:20480
    ds_read_b64_tr_b16 v[50:51], v12 offset:20992
    ds_read_b128 v[40:43], v10 offset:32768
    ds_read_b128 v[44:47], v10 offset:36864
    s_waitcnt lgkmcnt(8)
    ds_read_b64_tr_b16 v[60:61], v12 offset:22528
    ds_read_b64_tr_b16 v[62:63], v12 offset:23040
    ds_read_b128 v[52:55], v11 offset:32768
    v_mfma_f32_32x32x16_bf16 v[176:191], v[76:79], v[84:87], v[176:191]
    ds_read_b128 v[56:59], v11 offset:36864
    v_mfma_f32_32x32x16_bf16 v[192:207], v[80:83], v[84:87], v[192:207]
    v_mfma_f32_32x32x16_bf16 v[176:191], v[88:91], v[96:99], v[176:191]
    v_mfma_f32_32x32x16_bf16 v[192:207], v[92:95], v[96:99], v[192:207]
    v_mfma_f32_32x32x16_bf16 v[176:191], v[100:103], v[108:111], v[176:191]
    v_mfma_f32_32x32x16_bf16 v[192:207], v[104:107], v[108:111], v[192:207]
    s_mov_b32 s62, 0x3fb8aa3b
    s_mov_b32 s63, 0x3fb8aa3b
    v_mov_b32 v116, 0xb5c1a2a0
    v_pk_fma_f32 v[112:113], v[144:145], s[62:63], v[116:117] op_sel_hi:[1,1,0]
    v_pk_fma_f32 v[114:115], v[146:147], s[62:63], v[116:117] op_sel_hi:[1,1,0]
    v_exp_f32_e64 v112, v112 clamp
    v_exp_f32_e64 v113, v113 clamp
    v_exp_f32_e64 v114, v114 clamp
    v_exp_f32_e64 v115, v115 clamp
    v_max_f32 v144, 0x358637bd, v144
    v_max_f32 v145, 0x358637bd, v145
    v_max_f32 v146, 0x358637bd, v146
    v_max_f32 v147, 0x358637bd, v147
    v_pk_add_f32 v[144:145], v[144:145], v[112:113]
    v_pk_add_f32 v[146:147], v[146:147], v[114:115]
    v_pk_fma_f32 v[112:113], v[148:149], s[62:63], v[116:117] op_sel_hi:[1,1,0]
    v_pk_fma_f32 v[114:115], v[150:151], s[62:63], v[116:117] op_sel_hi:[1,1,0]
    v_exp_f32_e64 v112, v112 clamp
    v_exp_f32_e64 v113, v113 clamp
    v_exp_f32_e64 v114, v114 clamp
    v_exp_f32_e64 v115, v115 clamp
    v_max_f32 v148, 0x358637bd, v148
    v_max_f32 v149, 0x358637bd, v149
    v_max_f32 v150, 0x358637bd, v150
    v_max_f32 v151, 0x358637bd, v151
    v_pk_add_f32 v[148:149], v[148:149], v[112:113]
    v_pk_add_f32 v[150:151], v[150:151], v[114:115]
    v_pk_fma_f32 v[112:113], v[152:153], s[62:63], v[116:117] op_sel_hi:[1,1,0]
    v_pk_fma_f32 v[114:115], v[154:155], s[62:63], v[116:117] op_sel_hi:[1,1,0]
    v_exp_f32_e64 v112, v112 clamp
    v_exp_f32_e64 v113, v113 clamp
    v_exp_f32_e64 v114, v114 clamp
    v_exp_f32_e64 v115, v115 clamp
    v_max_f32 v152, 0x358637bd, v152
    v_max_f32 v153, 0x358637bd, v153
    v_max_f32 v154, 0x358637bd, v154
    v_max_f32 v155, 0x358637bd, v155
    v_pk_add_f32 v[152:153], v[152:153], v[112:113]
    v_pk_add_f32 v[154:155], v[154:155], v[114:115]
    v_pk_fma_f32 v[112:113], v[156:157], s[62:63], v[116:117] op_sel_hi:[1,1,0]
    v_pk_fma_f32 v[114:115], v[158:159], s[62:63], v[116:117] op_sel_hi:[1,1,0]
    v_exp_f32_e64 v112, v112 clamp
    v_exp_f32_e64 v113, v113 clamp
    v_exp_f32_e64 v114, v114 clamp
    v_exp_f32_e64 v115, v115 clamp
    v_max_f32 v156, 0x358637bd, v156
    v_max_f32 v157, 0x358637bd, v157
    v_max_f32 v158, 0x358637bd, v158
    v_max_f32 v159, 0x358637bd, v159
    v_pk_add_f32 v[156:157], v[156:157], v[112:113]
    v_pk_add_f32 v[158:159], v[158:159], v[114:115]
    v_cvt_pk_bf16_f32 v128, v144, v145
    v_cvt_pk_bf16_f32 v129, v146, v147
    v_cvt_pk_bf16_f32 v130, v148, v149
    v_cvt_pk_bf16_f32 v131, v150, v151
    v_cvt_pk_bf16_f32 v132, v152, v153
    v_cvt_pk_bf16_f32 v133, v154, v155
    v_cvt_pk_bf16_f32 v134, v156, v157
    v_cvt_pk_bf16_f32 v135, v158, v159
    v_pk_fma_f32 v[112:113], v[160:161], s[62:63], v[116:117] op_sel_hi:[1,1,0]
    v_pk_fma_f32 v[114:115], v[162:163], s[62:63], v[116:117] op_sel_hi:[1,1,0]
    v_exp_f32_e64 v112, v112 clamp
    v_exp_f32_e64 v113, v113 clamp
    v_exp_f32_e64 v114, v114 clamp
    v_exp_f32_e64 v115, v115 clamp
    v_max_f32 v160, 0x358637bd, v160
    v_max_f32 v161, 0x358637bd, v161
    v_max_f32 v162, 0x358637bd, v162
    v_max_f32 v163, 0x358637bd, v163
    v_pk_add_f32 v[160:161], v[160:161], v[112:113]
    v_pk_add_f32 v[162:163], v[162:163], v[114:115]
    v_pk_fma_f32 v[112:113], v[164:165], s[62:63], v[116:117] op_sel_hi:[1,1,0]
    v_pk_fma_f32 v[114:115], v[166:167], s[62:63], v[116:117] op_sel_hi:[1,1,0]
    v_exp_f32_e64 v112, v112 clamp
    v_exp_f32_e64 v113, v113 clamp
    v_exp_f32_e64 v114, v114 clamp
    v_exp_f32_e64 v115, v115 clamp
    v_max_f32 v164, 0x358637bd, v164
    v_max_f32 v165, 0x358637bd, v165
    v_max_f32 v166, 0x358637bd, v166
    v_max_f32 v167, 0x358637bd, v167
    v_pk_add_f32 v[164:165], v[164:165], v[112:113]
    v_pk_add_f32 v[166:167], v[166:167], v[114:115]
    v_pk_fma_f32 v[112:113], v[168:169], s[62:63], v[116:117] op_sel_hi:[1,1,0]
    v_pk_fma_f32 v[114:115], v[170:171], s[62:63], v[116:117] op_sel_hi:[1,1,0]
    v_exp_f32_e64 v112, v112 clamp
    v_exp_f32_e64 v113, v113 clamp
    v_exp_f32_e64 v114, v114 clamp
    v_exp_f32_e64 v115, v115 clamp
    v_max_f32 v168, 0x358637bd, v168
    v_max_f32 v169, 0x358637bd, v169
    v_max_f32 v170, 0x358637bd, v170
    v_max_f32 v171, 0x358637bd, v171
    v_pk_add_f32 v[168:169], v[168:169], v[112:113]
    v_pk_add_f32 v[170:171], v[170:171], v[114:115]
    v_pk_fma_f32 v[112:113], v[172:173], s[62:63], v[116:117] op_sel_hi:[1,1,0]
    v_pk_fma_f32 v[114:115], v[174:175], s[62:63], v[116:117] op_sel_hi:[1,1,0]
    v_exp_f32_e64 v112, v112 clamp
    v_exp_f32_e64 v113, v113 clamp
    v_exp_f32_e64 v114, v114 clamp
    v_exp_f32_e64 v115, v115 clamp
    v_max_f32 v172, 0x358637bd, v172
    v_max_f32 v173, 0x358637bd, v173
    v_max_f32 v174, 0x358637bd, v174
    v_max_f32 v175, 0x358637bd, v175
    v_pk_add_f32 v[172:173], v[172:173], v[112:113]
    v_pk_add_f32 v[174:175], v[174:175], v[114:115]
    v_cvt_pk_bf16_f32 v136, v160, v161
    v_cvt_pk_bf16_f32 v137, v162, v163
    v_cvt_pk_bf16_f32 v138, v164, v165
    v_cvt_pk_bf16_f32 v139, v166, v167
    v_cvt_pk_bf16_f32 v140, v168, v169
    v_cvt_pk_bf16_f32 v141, v170, v171
    v_cvt_pk_bf16_f32 v142, v172, v173
    v_cvt_pk_bf16_f32 v143, v174, v175
    v_mov_b32 v120, 0x3f803f80
    v_mov_b32 v121, 0x3f803f80
    v_mov_b32 v122, 0x3f803f80
    v_mov_b32 v123, 0x3f803f80
    s_nop 1
    v_mfma_f32_32x32x16_bf16 v[224:239], v[128:131], v[120:123], 0
    v_mfma_f32_32x32x16_bf16 v[224:239], v[132:135], v[120:123], v[224:239]
    v_mfma_f32_32x32x16_bf16 v[224:239], v[136:139], v[120:123], v[224:239]
    v_mfma_f32_32x32x16_bf16 v[224:239], v[140:143], v[120:123], v[224:239]
    s_waitcnt vmcnt(0) lgkmcnt(0)
    s_barrier
    v_mfma_f32_32x32x16_bf16 v[176:191], v[16:19], v[24:27], v[176:191]
    s_cmp_lg_u32 s33, 0
    s_cbranch_scc1 L_nosig_x
    s_mov_b32 s32, 65536
L_gettag_x:
    v_min_u32 v242, v240, v241
    v_cmp_ne_u32 vcc, 0, v242
    s_cbranch_vccnz L_havetag_x
    s_sub_u32 s32, s32, 1
    s_cbranch_scc1 L_havetag_x
    buffer_load_dwordx2 v[240:241], v13, s[4:7], 0 offen sc1
    s_waitcnt vmcnt(0)
    s_branch L_gettag_x
L_havetag_x:
    v_lshlrev_b32 v242, 14, v0
    s_lshl_b32 s28, s66, 11
    s_lshl_b32 s29, s67, 3
    s_add_u32 s28, s28, s29
    s_add_u32 s28, s28, 0xa40000
    s_mov_b32 exec_hi, 0
    buffer_store_dwordx2 v[240:241], v242, s[24:27], s28 offen sc1
    s_mov_b64 exec, -1
    ds_write_b64 v13, v[240:241] offset:0
L_nosig_x:
    ds_read_b64_tr_b16 v[72:73], v12 offset:24576
    ds_read_b64_tr_b16 v[74:75], v12 offset:25088
    ds_read_b128 v[64:67], v8 offset:49152
    ds_read_b128 v[68:71], v8 offset:53248
    ds_read_b64_tr_b16 v[84:85], v12 offset:26624
    ds_read_b64_tr_b16 v[86:87], v12 offset:27136
    ds_read_b128 v[76:79], v9 offset:49152
    v_mfma_f32_32x32x16_bf16 v[192:207], v[20:23], v[24:27], v[192:207]
    ds_read_b128 v[80:83], v9 offset:53248
    ds_read_b64_tr_b16 v[96:97], v12 offset:28672
    ds_read_b64_tr_b16 v[98:99], v12 offset:29184
    ds_read_b128 v[88:91], v10 offset:49152
    ds_read_b128 v[92:95], v10 offset:53248
    s_waitcnt lgkmcnt(8)
    ds_read_b64_tr_b16 v[108:109], v12 offset:30720
    ds_read_b64_tr_b16 v[110:111], v12 offset:31232
    v_mfma_f32_32x32x16_bf16 v[176:191], v[28:31], v[36:39], v[176:191]
    ds_read_b128 v[100:103], v11 offset:49152
    ds_read_b128 v[104:107], v11 offset:53248
    v_mfma_f32_32x32x16_bf16 v[192:207], v[32:35], v[36:39], v[192:207]
    v_mfma_f32_32x32x16_bf16 v[176:191], v[40:43], v[48:51], v[176:191]
    v_mfma_f32_32x32x16_bf16 v[192:207], v[44:47], v[48:51], v[192:207]
    v_mfma_f32_32x32x16_bf16 v[176:191], v[52:55], v[60:63], v[176:191]
    v_mfma_f32_32x32x16_bf16 v[192:207], v[56:59], v[60:63], v[192:207]
    s_waitcnt lgkmcnt(0)
    s_barrier
    v_mfma_f32_32x32x16_bf16 v[176:191], v[64:67], v[72:75], v[176:191]
    v_add_u32 v8, 0x10000, v8
    v_add_u32 v9, 0x10000, v9
    v_add_u32 v10, 0x10000, v10
    v_add_u32 v11, 0x10000, v11
    ds_read_b64_tr_b16 v[24:25], v12 offset:0
    ds_read_b64_tr_b16 v[26:27], v12 offset:512
    ds_read_b128 v[16:19], v8 offset:0
    ds_read_b128 v[20:23], v8 offset:4096
    ds_read_b64_tr_b16 v[36:37], v12 offset:2048
    ds_read_b64_tr_b16 v[38:39], v12 offset:2560
    ds_read_b128 v[28:31], v9 offset:0
    v_mfma_f32_32x32x16_bf16 v[192:207], v[68:71], v[72:75], v[192:207]
    ds_read_b128 v[32:35], v9 offset:4096
    ds_read_b64_tr_b16 v[48:49], v12 offset:4096
    ds_read_b64_tr_b16 v[50:51], v12 offset:4608
    ds_read_b128 v[40:43], v10 offset:0
    ds_read_b128 v[44:47], v10 offset:4096
    s_waitcnt lgkmcnt(8)
    ds_read_b64_tr_b16 v[60:61], v12 offset:6144
    ds_read_b64_tr_b16 v[62:63], v12 offset:6656
    v_mfma_f32_32x32x16_bf16 v[176:191], v[76:79], v[84:87], v[176:191]
    ds_read_b128 v[52:55], v11 offset:0
    ds_read_b128 v[56:59], v11 offset:4096
    ds_read_b64 v[244:245], v13 offset:0
    v_mfma_f32_32x32x16_bf16 v[192:207], v[80:83], v[84:87], v[192:207]
    v_mfma_f32_32x32x16_bf16 v[176:191], v[88:91], v[96:99], v[176:191]
    v_mfma_f32_32x32x16_bf16 v[192:207], v[92:95], v[96:99], v[192:207]
    v_mfma_f32_32x32x16_bf16 v[176:191], v[100:103], v[108:111], v[176:191]
    v_mfma_f32_32x32x16_bf16 v[192:207], v[104:107], v[108:111], v[192:207]
    s_waitcnt lgkmcnt(0)
    s_barrier
    v_mfma_f32_32x32x16_bf16 v[176:191], v[16:19], v[24:27], v[176:191]
    ds_read_b64_tr_b16 v[72:73], v12 offset:8192
    ds_read_b64_tr_b16 v[74:75], v12 offset:8704
    ds_read_b128 v[64:67], v8 offset:16384
    ds_read_b128 v[68:71], v8 offset:20480
    ds_read_b64_tr_b16 v[84:85], v12 offset:10240
    ds_read_b64_tr_b16 v[86:87], v12 offset:10752
    ds_read_b128 v[76:79], v9 offset:16384
    ds_read_b128 v[80:83], v9 offset:20480
    v_mfma_f32_32x32x16_bf16 v[192:207], v[20:23], v[24:27], v[192:207]
    ds_read_b64_tr_b16 v[96:97], v12 offset:12288
    ds_read_b64_tr_b16 v[98:99], v12 offset:12800
    ds_read_b128 v[88:91], v10 offset:16384
    ds_read_b128 v[92:95], v10 offset:20480
    s_waitcnt lgkmcnt(8)
    ds_read_b64_tr_b16 v[108:109], v12 offset:14336
    ds_read_b64_tr_b16 v[110:111], v12 offset:14848
    ds_read_b128 v[100:103], v11 offset:16384
    v_mfma_f32_32x32x16_bf16 v[176:191], v[28:31], v[36:39], v[176:191]
    ds_read_b128 v[104:107], v11 offset:20480
    v_readfirstlane_b32 s56, v244
    v_readfirstlane_b32 s57, v245
    v_mfma_f32_32x32x16_bf16 v[192:207], v[32:35], v[36:39], v[192:207]
    v_mfma_f32_32x32x16_bf16 v[176:191], v[40:43], v[48:51], v[176:191]
    v_mfma_f32_32x32x16_bf16 v[192:207], v[44:47], v[48:51], v[192:207]
    v_mfma_f32_32x32x16_bf16 v[176:191], v[52:55], v[60:63], v[176:191]
    v_mfma_f32_32x32x16_bf16 v[192:207], v[56:59], v[60:63], v[192:207]
    s_waitcnt lgkmcnt(0)
    s_barrier
    v_mfma_f32_32x32x16_bf16 v[176:191], v[64:67], v[72:75], v[176:191]
    ds_read_b64_tr_b16 v[24:25], v12 offset:16384
    ds_read_b64_tr_b16 v[26:27], v12 offset:16896
    ds_read_b128 v[16:19], v8 offset:32768
    ds_read_b128 v[20:23], v8 offset:36864
    ds_read_b64_tr_b16 v[36:37], v12 offset:18432
    ds_read_b64_tr_b16 v[38:39], v12 offset:18944
    ds_read_b128 v[28:31], v9 offset:32768
    ds_read_b128 v[32:35], v9 offset:36864
    v_mfma_f32_32x32x16_bf16 v[192:207], v[68:71], v[72:75], v[192:207]
    ds_read_b64_tr_b16 v[48:49], v12 offset:20480
    ds_read_b64_tr_b16 v[50:51], v12 offset:20992
    ds_read_b128 v[40:43], v10 offset:32768
    ds_read_b128 v[44:47], v10 offset:36864
    s_waitcnt lgkmcnt(8)
    ds_read_b64_tr_b16 v[60:61], v12 offset:22528
    ds_read_b64_tr_b16 v[62:63], v12 offset:23040
    ds_read_b128 v[52:55], v11 offset:32768
    v_mfma_f32_32x32x16_bf16 v[176:191], v[76:79], v[84:87], v[176:191]
    ds_read_b128 v[56:59], v11 offset:36864
    v_mfma_f32_32x32x16_bf16 v[192:207], v[80:83], v[84:87], v[192:207]
    v_mfma_f32_32x32x16_bf16 v[176:191], v[88:91], v[96:99], v[176:191]
    v_mfma_f32_32x32x16_bf16 v[192:207], v[92:95], v[96:99], v[192:207]
    v_mfma_f32_32x32x16_bf16 v[176:191], v[100:103], v[108:111], v[176:191]
    v_mfma_f32_32x32x16_bf16 v[192:207], v[104:107], v[108:111], v[192:207]
    s_waitcnt lgkmcnt(0)
    s_barrier
    v_mfma_f32_32x32x16_bf16 v[176:191], v[16:19], v[24:27], v[176:191]
    ds_read_b64_tr_b16 v[72:73], v12 offset:24576
    ds_read_b64_tr_b16 v[74:75], v12 offset:25088
    ds_read_b128 v[64:67], v8 offset:49152
    ds_read_b128 v[68:71], v8 offset:53248
    ds_read_b64_tr_b16 v[84:85], v12 offset:26624
    ds_read_b64_tr_b16 v[86:87], v12 offset:27136
    ds_read_b128 v[76:79], v9 offset:49152
    ds_read_b128 v[80:83], v9 offset:53248
    v_mfma_f32_32x32x16_bf16 v[192:207], v[20:23], v[24:27], v[192:207]
    ds_read_b64_tr_b16 v[96:97], v12 offset:28672
    ds_read_b64_tr_b16 v[98:99], v12 offset:29184
    ds_read_b128 v[88:91], v10 offset:49152
    ds_read_b128 v[92:95], v10 offset:53248
    s_waitcnt lgkmcnt(8)
    ds_read_b64_tr_b16 v[108:109], v12 offset:30720
    ds_read_b64_tr_b16 v[110:111], v12 offset:31232
    ds_read_b128 v[100:103], v11 offset:49152
    v_mfma_f32_32x32x16_bf16 v[176:191], v[28:31], v[36:39], v[176:191]
    ds_read_b128 v[104:107], v11 offset:53248
    v_mfma_f32_32x32x16_bf16 v[192:207], v[32:35], v[36:39], v[192:207]
    v_mfma_f32_32x32x16_bf16 v[176:191], v[40:43], v[48:51], v[176:191]
    v_mfma_f32_32x32x16_bf16 v[192:207], v[44:47], v[48:51], v[192:207]
    v_mfma_f32_32x32x16_bf16 v[176:191], v[52:55], v[60:63], v[176:191]
    v_mfma_f32_32x32x16_bf16 v[192:207], v[56:59], v[60:63], v[192:207]
    s_waitcnt lgkmcnt(0)
    v_mfma_f32_32x32x16_bf16 v[176:191], v[64:67], v[72:75], v[176:191]
    v_mfma_f32_32x32x16_bf16 v[192:207], v[68:71], v[72:75], v[192:207]
    v_mfma_f32_32x32x16_bf16 v[176:191], v[76:79], v[84:87], v[176:191]
    v_mfma_f32_32x32x16_bf16 v[192:207], v[80:83], v[84:87], v[192:207]
    v_mfma_f32_32x32x16_bf16 v[176:191], v[88:91], v[96:99], v[176:191]
    v_mfma_f32_32x32x16_bf16 v[192:207], v[92:95], v[96:99], v[192:207]
    v_mfma_f32_32x32x16_bf16 v[176:191], v[100:103], v[108:111], v[176:191]
    v_mfma_f32_32x32x16_bf16 v[192:207], v[104:107], v[108:111], v[192:207]
    v_mov_b32 v32, 0xb5c1a2a0
    s_mov_b32 s62, 0x3fb8aa3b
    s_mov_b32 s63, 0x3fb8aa3b
    s_xor_b32 s52, s52, 1048576
    s_nop 6
    v_cvt_pk_bf16_f32 v48, v176, v177
    v_cvt_pk_bf16_f32 v49, v178, v179
    v_cvt_pk_bf16_f32 v50, v180, v181
    v_cvt_pk_bf16_f32 v51, v182, v183
    s_nop 1
    v_mfma_f32_32x32x16_bf16 v[240:255], v[128:131], v[48:51], 0
    v_cvt_pk_bf16_f32 v52, v184, v185
    v_cvt_pk_bf16_f32 v53, v186, v187
    v_cvt_pk_bf16_f32 v54, v188, v189
    v_cvt_pk_bf16_f32 v55, v190, v191
    s_nop 1
    v_mfma_f32_32x32x16_bf16 v[240:255], v[132:135], v[52:55], v[240:255]
    v_cvt_pk_bf16_f32 v56, v192, v193
    v_cvt_pk_bf16_f32 v57, v194, v195
    v_cvt_pk_bf16_f32 v58, v196, v197
    v_cvt_pk_bf16_f32 v59, v198, v199
    s_nop 1
    v_mfma_f32_32x32x16_bf16 v[240:255], v[136:139], v[56:59], v[240:255]
    v_cvt_pk_bf16_f32 v60, v200, v201
    v_cvt_pk_bf16_f32 v61, v202, v203
    v_cvt_pk_bf16_f32 v62, v204, v205
    v_cvt_pk_bf16_f32 v63, v206, v207
    s_nop 1
    v_mfma_f32_32x32x16_bf16 v[240:255], v[140:143], v[60:63], v[240:255]
    v_mov_b32 v15, 0
    s_mov_b32 exec_lo, 0x110000
    s_mov_b32 exec_hi, 0x110000
    v_mov_b32 v15, 0x3f803f80
    s_mov_b64 exec, -1
    v_mov_b32 v45, 0xdddddddd
    v_mov_b32 v46, s56
    v_mov_b32 v47, s57
    v_mov_b32 v24, v15
    v_mov_b32 v25, v15
    v_mov_b32 v26, v15
    v_mov_b32 v27, v15
    v_mov_b32 v28, v15
    v_mov_b32 v29, v15
    v_mov_b32 v30, v15
    v_mov_b32 v31, v15
    v_mov_b32 v32, v15
    v_mov_b32 v33, v15
    v_mov_b32 v34, v15
    v_mov_b32 v35, v15
    s_mov_b32 exec_lo, 0xffff0000
    s_mov_b32 exec_hi, 0xffff0000
    v_mov_b32 v240, v224
    v_mov_b32 v241, v225
    v_mov_b32 v242, v226
    v_mov_b32 v243, v227
    v_mov_b32 v244, v228
    v_mov_b32 v245, v229
    v_mov_b32 v246, v230
    v_mov_b32 v247, v231
    s_not_b64 exec, exec
    v_mov_b32 v248, v232
    v_mov_b32 v249, v233
    v_mov_b32 v250, v234
    v_mov_b32 v251, v235
    v_mov_b32 v252, v236
    v_mov_b32 v253, v237
    v_mov_b32 v254, v238
    v_mov_b32 v255, v239
    s_mov_b64 exec, -1
    s_lshl_b32 s28, s72, 12
    s_add_u32 s28, s28, 139264
    v_add_u32 v8, s28, v1
    s_cmp_eq_u32 s54, 2
    s_cbranch_scc1 L_kvkeep
    ds_write_b128 v8, v[240:243] offset:0
    ds_write_b128 v8, v[244:247] offset:1024
    ds_write_b128 v8, v[248:251] offset:2048
    ds_write_b128 v8, v[252:255] offset:3072
L_kvkeep:
    v_mov_b32 v226, 0
    s_waitcnt lgkmcnt(0)
    s_branch L_attn
L_mm_y:
    s_waitcnt lgkmcnt(0)
    s_barrier
    ds_read_b128 v[16:19], v8 offset:0
    ds_read_b64_tr_b16 v[24:25], v12 offset:0
    ds_read_b64_tr_b16 v[26:27], v12 offset:512
    ds_read_b128 v[20:23], v8 offset:4096
    ds_read_b64_tr_b16 v[28:29], v12 offset:4096
    ds_read_b64_tr_b16 v[30:31], v12 offset:4608
    ds_read_b128 v[32:35], v9 offset:0
    ds_read_b64_tr_b16 v[40:41], v12 offset:2048
    ds_read_b64_tr_b16 v[42:43], v12 offset:2560
    ds_read_b128 v[36:39], v9 offset:4096
    ds_read_b64_tr_b16 v[44:45], v12 offset:6144
    ds_read_b64_tr_b16 v[46:47], v12 offset:6656
    s_waitcnt lgkmcnt(0)
    s_barrier
    v_mfma_f32_32x32x16_bf16 v[112:127], v[24:27], v[16:19], 0
    ds_read_b128 v[64:67], v10 offset:0
    ds_read_b64_tr_b16 v[72:73], v12 offset:8192
    ds_read_b64_tr_b16 v[74:75], v12 offset:8704
    ds_read_b128 v[68:71], v10 offset:4096
    ds_read_b64_tr_b16 v[76:77], v12 offset:12288
    ds_read_b64_tr_b16 v[78:79], v12 offset:12800
    ds_read_b128 v[80:83], v11 offset:0
    ds_read_b64_tr_b16 v[88:89], v12 offset:10240
    v_mfma_f32_32x32x16_bf16 v[128:143], v[24:27], v[20:23], 0
    ds_read_b64_tr_b16 v[90:91], v12 offset:10752
    ds_read_b128 v[84:87], v11 offset:4096
    ds_read_b64_tr_b16 v[92:93], v12 offset:14336
    ds_read_b64_tr_b16 v[94:95], v12 offset:14848
    s_mov_b32 s16, s48
    s_mov_b32 s17, s49
    s_mov_b32 s18, 0x400
    s_mov_b32 s19, 0x00020000
    buffer_load_dwordx4 v[220:223], v209, s[16:19], 0 offen
    buffer_load_dwordx4 v[224:227], v209, s[16:19], 0 offen offset:16
    v_lshlrev_b32 v230, 7, v0
    v_mfma_f32_32x32x16_bf16 v[144:159], v[16:19], v[28:31], 0
    v_mfma_f32_32x32x16_bf16 v[160:175], v[20:23], v[28:31], 0
    v_mfma_f32_32x32x16_bf16 v[112:127], v[40:43], v[32:35], v[112:127]
    v_mfma_f32_32x32x16_bf16 v[128:143], v[40:43], v[36:39], v[128:143]
    v_mfma_f32_32x32x16_bf16 v[144:159], v[32:35], v[44:47], v[144:159]
    v_mfma_f32_32x32x16_bf16 v[160:175], v[36:39], v[44:47], v[160:175]
    s_waitcnt lgkmcnt(0)
    s_barrier
    v_mfma_f32_32x32x16_bf16 v[112:127], v[72:75], v[64:67], v[112:127]
    ds_read_b128 v[16:19], v8 offset:16384
    ds_read_b64_tr_b16 v[24:25], v12 offset:16384
    ds_read_b64_tr_b16 v[26:27], v12 offset:16896
    ds_read_b128 v[20:23], v8 offset:20480
    ds_read_b64_tr_b16 v[28:29], v12 offset:20480
    ds_read_b64_tr_b16 v[30:31], v12 offset:20992
    ds_read_b128 v[32:35], v9 offset:16384
    ds_read_b64_tr_b16 v[40:41], v12 offset:18432
    v_mfma_f32_32x32x16_bf16 v[128:143], v[72:75], v[68:71], v[128:143]
    ds_read_b64_tr_b16 v[42:43], v12 offset:18944
    ds_read_b128 v[36:39], v9 offset:20480
    ds_read_b64_tr_b16 v[44:45], v12 offset:22528
    ds_read_b64_tr_b16 v[46:47], v12 offset:23040
    s_mov_b32 s24, s54
    s_mov_b32 s25, s55
    s_mov_b32 s26, 0x1000000
    s_mov_b32 s27, 0x00020000
    v_mfma_f32_32x32x16_bf16 v[144:159], v[64:67], v[76:79], v[144:159]
    s_mov_b32 s4, s52
    s_mov_b32 s5, s53
    s_mov_b32 s6, 0x100
    s_mov_b32 s7, 0x00020000
    v_lshlrev_b32 v210, 2, v210
    s_mov_b32 s12, s40
    s_mov_b32 s13, s41
    s_mov_b32 s14, 0x80000
    v_mfma_f32_32x32x16_bf16 v[160:175], v[68:71], v[76:79], v[160:175]
    s_mov_b32 s15, 0x00020000
    s_mov_b32 s16, s46
    s_mov_b32 s17, s47
    s_mov_b32 s18, 0x80000
    s_mov_b32 s19, 0x00020000
    s_mov_b32 s20, s50
    s_mov_b32 s21, s51
    s_mov_b32 s22, 0x200000
    v_mfma_f32_32x32x16_bf16 v[112:127], v[88:91], v[80:83], v[112:127]
    s_mov_b32 s23, 0x00020000
    s_and_b32 s28, s2, 7
    s_lshl_b32 s35, s28, 2
    s_bfe_u32 s28, s2, 0x20003
    s_add_u32 s35, s35, s28
    s_lshr_b32 s64, s2, 5
    s_lshl_b32 s68, s2, 11
    s_add_u32 s68, s68, 0xa40000
    v_mfma_f32_32x32x16_bf16 v[128:143], v[88:91], v[84:87], v[128:143]
    v_mfma_f32_32x32x16_bf16 v[144:159], v[80:83], v[92:95], v[144:159]
    v_mfma_f32_32x32x16_bf16 v[160:175], v[84:87], v[92:95], v[160:175]
    s_waitcnt lgkmcnt(0)
    s_barrier
    v_mfma_f32_32x32x16_bf16 v[112:127], v[24:27], v[16:19], v[112:127]
    ds_read_b128 v[64:67], v10 offset:16384
    ds_read_b64_tr_b16 v[72:73], v12 offset:24576
    ds_read_b64_tr_b16 v[74:75], v12 offset:25088
    ds_read_b128 v[68:71], v10 offset:20480
    ds_read_b64_tr_b16 v[76:77], v12 offset:28672
    ds_read_b64_tr_b16 v[78:79], v12 offset:29184
    ds_read_b128 v[80:83], v11 offset:16384
    ds_read_b64_tr_b16 v[88:89], v12 offset:26624
    v_mfma_f32_32x32x16_bf16 v[128:143], v[24:27], v[20:23], v[128:143]
    ds_read_b64_tr_b16 v[90:91], v12 offset:27136
    ds_read_b128 v[84:87], v11 offset:20480
    ds_read_b64_tr_b16 v[92:93], v12 offset:30720
    ds_read_b64_tr_b16 v[94:95], v12 offset:31232
    s_lshl_b32 s65, s64, 3
    s_add_u32 s65, s65, s33
    v_and_b32 v4, 15, v0
    v_lshlrev_b32 v4, 4, v4
    v_mfma_f32_32x32x16_bf16 v[144:159], v[16:19], v[28:31], v[144:159]
    v_lshrrev_b32 v232, 5, v0
    v_lshl_add_u32 v4, v232, 8, v4
    v_add_u32 v4, 0x10000, v4
    v_lshrrev_b32 v233, 3, v0
    v_bfe_u32 v234, v0, 4, 1
    v_lshlrev_b32 v235, 2, v234
    v_and_b32 v5, 7, v0
    v_xor_b32 v5, v5, v235
    v_mfma_f32_32x32x16_bf16 v[160:175], v[20:23], v[28:31], v[160:175]
    v_lshlrev_b32 v5, 4, v5
    v_lshl_add_u32 v5, v233, 10, v5
    v_bfe_u32 v233, v0, 2, 2
    v_lshlrev_b32 v6, 7, v233
    v_lshl_add_u32 v6, v232, 9, v6
    v_lshrrev_b32 v233, 1, v233
    v_lshl_add_u32 v6, v233, 6, v6
    v_lshl_add_u32 v6, v234, 5, v6
    v_mfma_f32_32x32x16_bf16 v[112:127], v[40:43], v[32:35], v[112:127]
    v_and_b32 v233, 1, v0
    v_lshl_add_u32 v6, v233, 4, v6
    v_bfe_u32 v234, v0, 1, 1
    v_lshl_add_u32 v6, v234, 3, v6
    v_and_b32 v233, 7, v0
    v_lshlrev_b32 v14, 14, v233
    s_lshl_b32 s70, s33, 10
    s_and_b32 s71, s33, 1
    v_mfma_f32_32x32x16_bf16 v[128:143], v[40:43], v[36:39], v[128:143]
    v_mfma_f32_32x32x16_bf16 v[144:159], v[32:35], v[44:47], v[144:159]
    v_mfma_f32_32x32x16_bf16 v[160:175], v[36:39], v[44:47], v[160:175]
    s_waitcnt lgkmcnt(0)
    s_barrier
    v_mfma_f32_32x32x16_bf16 v[112:127], v[72:75], v[64:67], v[112:127]
    ds_read_b128 v[16:19], v8 offset:32768
    ds_read_b64_tr_b16 v[24:25], v12 offset:0
    ds_read_b64_tr_b16 v[26:27], v12 offset:512
    ds_read_b128 v[20:23], v8 offset:36864
    ds_read_b64_tr_b16 v[28:29], v12 offset:4096
    ds_read_b64_tr_b16 v[30:31], v12 offset:4608
    ds_read_b128 v[32:35], v9 offset:32768
    ds_read_b64_tr_b16 v[40:41], v12 offset:2048
    v_mfma_f32_32x32x16_bf16 v[128:143], v[72:75], v[68:71], v[128:143]
    ds_read_b64_tr_b16 v[42:43], v12 offset:2560
    ds_read_b128 v[36:39], v9 offset:36864
    ds_read_b64_tr_b16 v[44:45], v12 offset:6144
    ds_read_b64_tr_b16 v[46:47], v12 offset:6656
    s_lshr_b32 s72, s33, 1
    s_bfe_u32 s73, s2, 0x30003
    s_lshl_b32 s28, s35, 16
    s_add_u32 s78, s28, s70
    v_mfma_f32_32x32x16_bf16 v[144:159], v[64:67], v[76:79], v[144:159]
    s_lshl_b32 s29, s65, 10
    s_add_u32 s79, s28, s29
    s_add_u32 s79, s79, 0x600000
    s_lshl_b32 s29, s72, 13
    s_add_u32 s42, s28, s29
    s_lshl_b32 s29, s71, 10
    s_add_u32 s42, s42, s29
    s_add_u32 s42, s42, 0x800000
    v_mfma_f32_32x32x16_bf16 v[160:175], v[68:71], v[76:79], v[160:175]
    s_lshl_b32 s28, s65, 16
    s_lshl_b32 s29, s35, 10
    s_add_u32 s43, s28, s29
    s_add_u32 s43, s43, 0xb00000
    s_lshl_b32 s49, s65, 7
    s_add_u32 s49, s49, 0xa00000
    s_lshl_b32 s28, s33, 16
    s_lshl_b32 s29, s73, 7
    v_mfma_f32_32x32x16_bf16 v[112:127], v[88:91], v[80:83], v[112:127]
    s_add_u32 s37, s28, s29
    s_lshl_b32 s48, s33, 13
    s_and_b32 s28, s48, 0x8000
    s_add_u32 s48, s48, s28
    s_andn2_b32 s28, s48, 0x2000
    v_add_u32 v6, s28, v6
    s_cmp_eq_u32 s72, 1
    s_cselect_b32 s53, 5, 4
    v_mfma_f32_32x32x16_bf16 v[128:143], v[88:91], v[84:87], v[128:143]
    v_mfma_f32_32x32x16_bf16 v[144:159], v[80:83], v[92:95], v[144:159]
    v_mfma_f32_32x32x16_bf16 v[160:175], v[84:87], v[92:95], v[160:175]
    s_waitcnt lgkmcnt(0)
    s_barrier
    v_mfma_f32_32x32x16_bf16 v[112:127], v[24:27], v[16:19], v[112:127]
    ds_read_b128 v[64:67], v10 offset:32768
    ds_read_b64_tr_b16 v[72:73], v12 offset:8192
    ds_read_b64_tr_b16 v[74:75], v12 offset:8704
    ds_read_b128 v[68:71], v10 offset:36864
    ds_read_b64_tr_b16 v[76:77], v12 offset:12288
    ds_read_b64_tr_b16 v[78:79], v12 offset:12800
    ds_read_b128 v[80:83], v11 offset:32768
    ds_read_b64_tr_b16 v[88:89], v12 offset:10240
    v_mfma_f32_32x32x16_bf16 v[128:143], v[24:27], v[20:23], v[128:143]
    ds_read_b64_tr_b16 v[90:91], v12 offset:10752
    ds_read_b128 v[84:87], v11 offset:36864
    ds_read_b64_tr_b16 v[92:93], v12 offset:14336
    ds_read_b64_tr_b16 v[94:95], v12 offset:14848
    s_waitcnt vmcnt(0)
    v_dot2_f32_bf16 v211, v212, v220, 0
    v_dot2_f32_bf16 v211, v213, v221, v211
    v_dot2_f32_bf16 v211, v214, v222, v211
    v_dot2_f32_bf16 v211, v215, v223, v211
    v_mfma_f32_32x32x16_bf16 v[144:159], v[16:19], v[28:31], v[144:159]
    v_dot2_f32_bf16 v211, v216, v224, v211
    v_dot2_f32_bf16 v211, v217, v225, v211
    v_dot2_f32_bf16 v211, v218, v226, v211
    v_dot2_f32_bf16 v211, v219, v227, v211
    v_mfma_f32_32x32x16_bf16 v[160:175], v[20:23], v[28:31], v[160:175]
    v_mfma_f32_32x32x16_bf16 v[112:127], v[40:43], v[32:35], v[112:127]
    v_mfma_f32_32x32x16_bf16 v[128:143], v[40:43], v[36:39], v[128:143]
    v_mfma_f32_32x32x16_bf16 v[144:159], v[32:35], v[44:47], v[144:159]
    v_mfma_f32_32x32x16_bf16 v[160:175], v[36:39], v[44:47], v[160:175]
    s_waitcnt lgkmcnt(0)
    s_barrier
    v_mfma_f32_32x32x16_bf16 v[112:127], v[72:75], v[64:67], v[112:127]
    ds_read_b128 v[16:19], v8 offset:49152
    ds_read_b64_tr_b16 v[24:25], v12 offset:16384
    ds_read_b64_tr_b16 v[26:27], v12 offset:16896
    ds_read_b128 v[20:23], v8 offset:53248
    ds_read_b64_tr_b16 v[28:29], v12 offset:20480
    ds_read_b64_tr_b16 v[30:31], v12 offset:20992
    ds_read_b128 v[32:35], v9 offset:49152
    ds_read_b64_tr_b16 v[40:41], v12 offset:18432
    v_mfma_f32_32x32x16_bf16 v[128:143], v[72:75], v[68:71], v[128:143]
    ds_read_b64_tr_b16 v[42:43], v12 offset:18944
    ds_read_b128 v[36:39], v9 offset:53248
    ds_read_b64_tr_b16 v[44:45], v12 offset:22528
    ds_read_b64_tr_b16 v[46:47], v12 offset:23040
    v_add_f32_dpp v211, v211, v211 row_ror:8 row_mask:0xf bank_mask:0xf
    s_nop 1
    v_add_f32_dpp v211, v211, v211 row_ror:4 row_mask:0xf bank_mask:0xf
    s_nop 1
    v_add_f32_dpp v211, v211, v211 row_ror:2 row_mask:0xf bank_mask:0xf
    s_nop 1
    v_add_f32_dpp v211, v211, v211 row_ror:1 row_mask:0xf bank_mask:0xf
    v_mfma_f32_32x32x16_bf16 v[144:159], v[64:67], v[76:79], v[144:159]
    v_mov_b32 v212, v211
    s_nop 1
    v_permlane16_swap_b32 v211, v212
    v_add_f32 v211, v211, v212
    v_mfma_f32_32x32x16_bf16 v[160:175], v[68:71], v[76:79], v[160:175]
    v_mfma_f32_32x32x16_bf16 v[112:127], v[88:91], v[80:83], v[112:127]
    v_mfma_f32_32x32x16_bf16 v[128:143], v[88:91], v[84:87], v[128:143]
    v_mfma_f32_32x32x16_bf16 v[144:159], v[80:83], v[92:95], v[144:159]
    v_mfma_f32_32x32x16_bf16 v[160:175], v[84:87], v[92:95], v[160:175]
    s_waitcnt lgkmcnt(0)
    s_barrier
    v_mfma_f32_32x32x16_bf16 v[112:127], v[24:27], v[16:19], v[112:127]
    ds_read_b128 v[64:67], v10 offset:49152
    ds_read_b64_tr_b16 v[72:73], v12 offset:24576
    ds_read_b64_tr_b16 v[74:75], v12 offset:25088
    ds_read_b128 v[68:71], v10 offset:53248
    ds_read_b64_tr_b16 v[76:77], v12 offset:28672
    ds_read_b64_tr_b16 v[78:79], v12 offset:29184
    ds_read_b128 v[80:83], v11 offset:49152
    ds_read_b64_tr_b16 v[88:89], v12 offset:26624
    v_mfma_f32_32x32x16_bf16 v[128:143], v[24:27], v[20:23], v[128:143]
    ds_read_b64_tr_b16 v[90:91], v12 offset:27136
    ds_read_b128 v[84:87], v11 offset:53248
    ds_read_b64_tr_b16 v[92:93], v12 offset:30720
    ds_read_b64_tr_b16 v[94:95], v12 offset:31232
    v_mul_f32 v211, 0xbfb8aa3b, v211
    v_exp_f32 v211, v211
    s_nop 0
    v_add_f32 v211, 1.0, v211
    v_rcp_f32 v211, v211
    v_mfma_f32_32x32x16_bf16 v[144:159], v[16:19], v[28:31], v[144:159]
    s_mov_b32 s3, 0xa00000
    s_mov_b32 exec_lo, 1
    s_mov_b32 exec_hi, 1
    buffer_store_dword v211, v210, s[24:27], s3 offen sc1
    s_mov_b64 exec, -1
    v_mfma_f32_32x32x16_bf16 v[160:175], v[20:23], v[28:31], v[160:175]
    v_mfma_f32_32x32x16_bf16 v[112:127], v[40:43], v[32:35], v[112:127]
    v_mfma_f32_32x32x16_bf16 v[128:143], v[40:43], v[36:39], v[128:143]
    v_mfma_f32_32x32x16_bf16 v[144:159], v[32:35], v[44:47], v[144:159]
    v_mfma_f32_32x32x16_bf16 v[160:175], v[36:39], v[44:47], v[160:175]
    s_waitcnt lgkmcnt(0)
    s_barrier
    v_mfma_f32_32x32x16_bf16 v[112:127], v[72:75], v[64:67], v[112:127]
    v_add_u32 v8, 0x10000, v8
    v_add_u32 v9, 0x10000, v9
    v_add_u32 v10, 0x10000, v10
    v_add_u32 v11, 0x10000, v11
    ds_read_b128 v[16:19], v8 offset:0
    ds_read_b64_tr_b16 v[24:25], v12 offset:0
    ds_read_b64_tr_b16 v[26:27], v12 offset:512
    ds_read_b128 v[20:23], v8 offset:4096
    ds_read_b64_tr_b16 v[28:29], v12 offset:4096
    ds_read_b64_tr_b16 v[30:31], v12 offset:4608
    ds_read_b128 v[32:35], v9 offset:0
    v_mfma_f32_32x32x16_bf16 v[128:143], v[72:75], v[68:71], v[128:143]
    ds_read_b64_tr_b16 v[40:41], v12 offset:2048
    ds_read_b64_tr_b16 v[42:43], v12 offset:2560
    ds_read_b128 v[36:39], v9 offset:4096
    ds_read_b64_tr_b16 v[44:45], v12 offset:6144
    ds_read_b64_tr_b16 v[46:47], v12 offset:6656
    s_cmp_eq_u32 s72, 0
    s_cselect_b32 s53, 2, s53
    s_lshl_b32 s53, s53, 14
    v_mfma_f32_32x32x16_bf16 v[144:159], v[64:67], v[76:79], v[144:159]
    v_xor_b32 v7, 64, v6
    s_lshr_b32 s28, s2, 6
    s_lshl_b32 s28, s28, 1
    s_add_u32 s28, s28, s71
    s_and_b32 s29, s2, 7
    s_lshl_b32 s29, s29, 3
    s_add_u32 s74, s28, s29
    s_lshl_b32 s28, s74, 16
    v_mfma_f32_32x32x16_bf16 v[160:175], v[68:71], v[76:79], v[160:175]
    s_lshl_b32 s29, s72, 13
    s_add_u32 s36, s28, s29
    s_add_u32 s36, s36, 0xb00000
    s_lshl_b32 s29, s72, 6
    s_add_u32 s28, s64, s29
    s_lshl_b32 s28, s28, 11
    s_lshl_b32 s29, s71, 5
    s_add_u32 s29, s29, s35
    v_mfma_f32_32x32x16_bf16 v[112:127], v[88:91], v[80:83], v[112:127]
    s_lshl_b32 s29, s29, 3
    s_add_u32 s28, s28, s29
    s_add_u32 s77, s28, 0xa40000
    s_lshl_b32 s28, s71, 8
    s_lshl_b32 s29, s72, 6
    s_add_u32 s28, s28, s29
    s_add_u32 s75, s28, s68
    s_mov_b32 s58, 0xffff
    v_mfma_f32_32x32x16_bf16 v[128:143], v[88:91], v[84:87], v[128:143]
    s_mov_b32 s59, 0xffff
    v_mfma_f32_32x32x16_bf16 v[144:159], v[80:83], v[92:95], v[144:159]
    v_mfma_f32_32x32x16_bf16 v[160:175], v[84:87], v[92:95], v[160:175]
    s_waitcnt lgkmcnt(0)
    s_barrier
    v_mfma_f32_32x32x16_bf16 v[112:127], v[24:27], v[16:19], v[112:127]
    ds_read_b128 v[64:67], v10 offset:0
    ds_read_b64_tr_b16 v[72:73], v12 offset:8192
    ds_read_b64_tr_b16 v[74:75], v12 offset:8704
    ds_read_b128 v[68:71], v10 offset:4096
    ds_read_b64_tr_b16 v[76:77], v12 offset:12288
    ds_read_b64_tr_b16 v[78:79], v12 offset:12800
    ds_read_b128 v[80:83], v11 offset:0
    ds_read_b64_tr_b16 v[88:89], v12 offset:10240
    v_mfma_f32_32x32x16_bf16 v[128:143], v[24:27], v[20:23], v[128:143]
    ds_read_b64_tr_b16 v[90:91], v12 offset:10752
    ds_read_b128 v[84:87], v11 offset:4096
    ds_read_b64_tr_b16 v[92:93], v12 offset:14336
    ds_read_b64_tr_b16 v[94:95], v12 offset:14848
    v_and_b32 v2, 0x33, v0
    v_bfe_u32 v232, v0, 2, 1
    v_lshl_or_b32 v2, v232, 3, v2
    v_bfe_u32 v232, v0, 3, 1
    v_mfma_f32_32x32x16_bf16 v[144:159], v[16:19], v[28:31], v[144:159]
    v_lshl_or_b32 v2, v232, 2, v2
    v_lshlrev_b32 v2, 4, v2
    v_bfe_u32 v232, v0, 4, 1
    v_lshl_add_u32 v3, v232, 16, v4
    v_mov_b32 v13, 0
    s_lshl_b32 s28, s66, 1
    s_add_u32 s28, s28, s72
    s_lshl_b32 s29, s28, 17
    v_mfma_f32_32x32x16_bf16 v[160:175], v[20:23], v[28:31], v[160:175]
    s_lshl_b32 s28, s67, 11
    s_add_u32 s55, s29, s28
    s_xor_b32 s55, s55, 1048576
    s_lshl_b32 s28, s67, 1
    s_add_u32 s28, s28, s71
    s_lshl_b32 s28, s28, 11
    s_add_u32 s52, s29, s28
    s_mov_b32 s62, 0x3eb8aa3b
    v_mfma_f32_32x32x16_bf16 v[112:127], v[40:43], v[32:35], v[112:127]
    s_mov_b32 s63, 0x3eb8aa3b
    s_mov_b32 s54, 1
    v_mov_b32 v176, 0x358637bd
    v_mov_b32 v177, 0x358637bd
    v_mov_b32 v178, 0x358637bd
    v_mov_b32 v179, 0x358637bd
    v_mov_b32 v180, 0x358637bd
    v_mov_b32 v181, 0x358637bd
    v_mfma_f32_32x32x16_bf16 v[128:143], v[40:43], v[36:39], v[128:143]
    v_mfma_f32_32x32x16_bf16 v[144:159], v[32:35], v[44:47], v[144:159]
    v_mfma_f32_32x32x16_bf16 v[160:175], v[36:39], v[44:47], v[160:175]
    s_waitcnt lgkmcnt(0)
    s_barrier
    v_mfma_f32_32x32x16_bf16 v[112:127], v[72:75], v[64:67], v[112:127]
    ds_read_b128 v[16:19], v8 offset:16384
    ds_read_b64_tr_b16 v[24:25], v12 offset:16384
    ds_read_b64_tr_b16 v[26:27], v12 offset:16896
    ds_read_b128 v[20:23], v8 offset:20480
    ds_read_b64_tr_b16 v[28:29], v12 offset:20480
    ds_read_b64_tr_b16 v[30:31], v12 offset:20992
    ds_read_b128 v[32:35], v9 offset:16384
    ds_read_b64_tr_b16 v[40:41], v12 offset:18432
    v_mfma_f32_32x32x16_bf16 v[128:143], v[72:75], v[68:71], v[128:143]
    ds_read_b64_tr_b16 v[42:43], v12 offset:18944
    ds_read_b128 v[36:39], v9 offset:20480
    ds_read_b64_tr_b16 v[44:45], v12 offset:22528
    ds_read_b64_tr_b16 v[46:47], v12 offset:23040
    v_mov_b32 v182, 0x358637bd
    v_mov_b32 v183, 0x358637bd
    v_mov_b32 v184, 0x358637bd
    v_mov_b32 v185, 0x358637bd
    v_mfma_f32_32x32x16_bf16 v[144:159], v[64:67], v[76:79], v[144:159]
    v_mov_b32 v186, 0x358637bd
    v_mov_b32 v187, 0x358637bd
    v_mov_b32 v188, 0x358637bd
    v_mov_b32 v189, 0x358637bd
    v_mov_b32 v190, 0x358637bd
    v_mov_b32 v191, 0x358637bd
    v_mov_b32 v192, 0x358637bd
    v_mov_b32 v193, 0x358637bd
    v_mfma_f32_32x32x16_bf16 v[160:175], v[68:71], v[76:79], v[160:175]
    v_mov_b32 v194, 0x358637bd
    v_mov_b32 v195, 0x358637bd
    v_mov_b32 v196, 0x358637bd
    v_mov_b32 v197, 0x358637bd
    v_mov_b32 v198, 0x358637bd
    v_mov_b32 v199, 0x358637bd
    v_mov_b32 v200, 0x358637bd
    v_mov_b32 v201, 0x358637bd
    v_mfma_f32_32x32x16_bf16 v[112:127], v[88:91], v[80:83], v[112:127]
    v_mov_b32 v202, 0x358637bd
    v_mov_b32 v203, 0x358637bd
    v_mov_b32 v204, 0x358637bd
    v_mov_b32 v205, 0x358637bd
    v_mov_b32 v206, 0x358637bd
    v_mov_b32 v207, 0x358637bd
    v_mfma_f32_32x32x16_bf16 v[128:143], v[88:91], v[84:87], v[128:143]
    v_mfma_f32_32x32x16_bf16 v[144:159], v[80:83], v[92:95], v[144:159]
    v_mfma_f32_32x32x16_bf16 v[160:175], v[84:87], v[92:95], v[160:175]
    s_waitcnt lgkmcnt(0)
    s_barrier
    v_mfma_f32_32x32x16_bf16 v[112:127], v[24:27], v[16:19], v[112:127]
    ds_read_b128 v[64:67], v10 offset:16384
    ds_read_b64_tr_b16 v[72:73], v12 offset:24576
    ds_read_b64_tr_b16 v[74:75], v12 offset:25088
    ds_read_b128 v[68:71], v10 offset:20480
    ds_read_b64_tr_b16 v[76:77], v12 offset:28672
    ds_read_b64_tr_b16 v[78:79], v12 offset:29184
    ds_read_b128 v[80:83], v11 offset:16384
    ds_read_b64_tr_b16 v[88:89], v12 offset:26624
    v_mfma_f32_32x32x16_bf16 v[128:143], v[24:27], v[20:23], v[128:143]
    ds_read_b64_tr_b16 v[90:91], v12 offset:27136
    ds_read_b128 v[84:87], v11 offset:20480
    ds_read_b64_tr_b16 v[92:93], v12 offset:30720
    ds_read_b64_tr_b16 v[94:95], v12 offset:31232
    v_mfma_f32_32x32x16_bf16 v[144:159], v[16:19], v[28:31], v[144:159]
    v_mfma_f32_32x32x16_bf16 v[160:175], v[20:23], v[28:31], v[160:175]
    v_mfma_f32_32x32x16_bf16 v[112:127], v[40:43], v[32:35], v[112:127]
    v_mfma_f32_32x32x16_bf16 v[128:143], v[40:43], v[36:39], v[128:143]
    v_mfma_f32_32x32x16_bf16 v[144:159], v[32:35], v[44:47], v[144:159]
    v_mfma_f32_32x32x16_bf16 v[160:175], v[36:39], v[44:47], v[160:175]
    s_waitcnt lgkmcnt(0)
    s_barrier
    v_mfma_f32_32x32x16_bf16 v[112:127], v[72:75], v[64:67], v[112:127]
    ds_read_b128 v[16:19], v8 offset:32768
    ds_read_b64_tr_b16 v[24:25], v12 offset:0
    ds_read_b64_tr_b16 v[26:27], v12 offset:512
    ds_read_b128 v[20:23], v8 offset:36864
    ds_read_b64_tr_b16 v[28:29], v12 offset:4096
    ds_read_b64_tr_b16 v[30:31], v12 offset:4608
    ds_read_b128 v[32:35], v9 offset:32768
    ds_read_b64_tr_b16 v[40:41], v12 offset:2048
    v_mfma_f32_32x32x16_bf16 v[128:143], v[72:75], v[68:71], v[128:143]
    ds_read_b64_tr_b16 v[42:43], v12 offset:2560
    ds_read_b128 v[36:39], v9 offset:36864
    ds_read_b64_tr_b16 v[44:45], v12 offset:6144
    ds_read_b64_tr_b16 v[46:47], v12 offset:6656
    s_cmp_lg_u32 s33, 0
    s_cbranch_scc1 L_notag_y
    buffer_load_dwordx2 v[240:241], v13, s[4:7], 0 offen sc1
L_notag_y:
    v_mfma_f32_32x32x16_bf16 v[144:159], v[64:67], v[76:79], v[144:159]
    v_mfma_f32_32x32x16_bf16 v[160:175], v[68:71], v[76:79], v[160:175]
    v_mfma_f32_32x32x16_bf16 v[112:127], v[88:91], v[80:83], v[112:127]
    v_mfma_f32_32x32x16_bf16 v[128:143], v[88:91], v[84:87], v[128:143]
    v_mfma_f32_32x32x16_bf16 v[144:159], v[80:83], v[92:95], v[144:159]
    v_mfma_f32_32x32x16_bf16 v[160:175], v[84:87], v[92:95], v[160:175]
    s_waitcnt lgkmcnt(0)
    s_barrier
    v_mfma_f32_32x32x16_bf16 v[112:127], v[24:27], v[16:19], v[112:127]
    ds_read_b128 v[64:67], v10 offset:32768
    ds_read_b64_tr_b16 v[72:73], v12 offset:8192
    ds_read_b64_tr_b16 v[74:75], v12 offset:8704
    ds_read_b128 v[68:71], v10 offset:36864
    ds_read_b64_tr_b16 v[76:77], v12 offset:12288
    ds_read_b64_tr_b16 v[78:79], v12 offset:12800
    ds_read_b128 v[80:83], v11 offset:32768
    ds_read_b64_tr_b16 v[88:89], v12 offset:10240
    v_mfma_f32_32x32x16_bf16 v[128:143], v[24:27], v[20:23], v[128:143]
    ds_read_b64_tr_b16 v[90:91], v12 offset:10752
    ds_read_b128 v[84:87], v11 offset:36864
    ds_read_b64_tr_b16 v[92:93], v12 offset:14336
    ds_read_b64_tr_b16 v[94:95], v12 offset:14848
    v_mfma_f32_32x32x16_bf16 v[144:159], v[16:19], v[28:31], v[144:159]
    v_mfma_f32_32x32x16_bf16 v[160:175], v[20:23], v[28:31], v[160:175]
    v_mfma_f32_32x32x16_bf16 v[112:127], v[40:43], v[32:35], v[112:127]
    v_mfma_f32_32x32x16_bf16 v[128:143], v[40:43], v[36:39], v[128:143]
    v_mfma_f32_32x32x16_bf16 v[144:159], v[32:35], v[44:47], v[144:159]
    v_mfma_f32_32x32x16_bf16 v[160:175], v[36:39], v[44:47], v[160:175]
    s_waitcnt lgkmcnt(0)
    s_barrier
    v_mfma_f32_32x32x16_bf16 v[112:127], v[72:75], v[64:67], v[112:127]
    ds_read_b128 v[16:19], v8 offset:49152
    ds_read_b64_tr_b16 v[24:25], v12 offset:16384
    ds_read_b64_tr_b16 v[26:27], v12 offset:16896
    ds_read_b128 v[20:23], v8 offset:53248
    ds_read_b64_tr_b16 v[28:29], v12 offset:20480
    ds_read_b64_tr_b16 v[30:31], v12 offset:20992
    ds_read_b128 v[32:35], v9 offset:49152
    ds_read_b64_tr_b16 v[40:41], v12 offset:18432
    v_mfma_f32_32x32x16_bf16 v[128:143], v[72:75], v[68:71], v[128:143]
    ds_read_b64_tr_b16 v[42:43], v12 offset:18944
    ds_read_b128 v[36:39], v9 offset:53248
    ds_read_b64_tr_b16 v[44:45], v12 offset:22528
    ds_read_b64_tr_b16 v[46:47], v12 offset:23040
    v_mfma_f32_32x32x16_bf16 v[144:159], v[64:67], v[76:79], v[144:159]
    v_mfma_f32_32x32x16_bf16 v[160:175], v[68:71], v[76:79], v[160:175]
    v_mfma_f32_32x32x16_bf16 v[112:127], v[88:91], v[80:83], v[112:127]
    v_mfma_f32_32x32x16_bf16 v[128:143], v[88:91], v[84:87], v[128:143]
    v_mfma_f32_32x32x16_bf16 v[144:159], v[80:83], v[92:95], v[144:159]
    v_mfma_f32_32x32x16_bf16 v[160:175], v[84:87], v[92:95], v[160:175]
    s_waitcnt lgkmcnt(0)
    s_barrier
    v_mfma_f32_32x32x16_bf16 v[112:127], v[24:27], v[16:19], v[112:127]
    ds_read_b128 v[64:67], v10 offset:49152
    ds_read_b64_tr_b16 v[72:73], v12 offset:24576
    ds_read_b64_tr_b16 v[74:75], v12 offset:25088
    ds_read_b128 v[68:71], v10 offset:53248
    ds_read_b64_tr_b16 v[76:77], v12 offset:28672
    ds_read_b64_tr_b16 v[78:79], v12 offset:29184
    ds_read_b128 v[80:83], v11 offset:49152
    ds_read_b64_tr_b16 v[88:89], v12 offset:26624
    v_mfma_f32_32x32x16_bf16 v[128:143], v[24:27], v[20:23], v[128:143]
    ds_read_b64_tr_b16 v[90:91], v12 offset:27136
    ds_read_b128 v[84:87], v11 offset:53248
    ds_read_b64_tr_b16 v[92:93], v12 offset:30720
    ds_read_b64_tr_b16 v[94:95], v12 offset:31232
    v_mfma_f32_32x32x16_bf16 v[144:159], v[16:19], v[28:31], v[144:159]
    v_mfma_f32_32x32x16_bf16 v[160:175], v[20:23], v[28:31], v[160:175]
    v_mfma_f32_32x32x16_bf16 v[112:127], v[40:43], v[32:35], v[112:127]
    v_mfma_f32_32x32x16_bf16 v[128:143], v[40:43], v[36:39], v[128:143]
    v_mfma_f32_32x32x16_bf16 v[144:159], v[32:35], v[44:47], v[144:159]
    v_mfma_f32_32x32x16_bf16 v[160:175], v[36:39], v[44:47], v[160:175]
    s_waitcnt lgkmcnt(0)
    s_barrier
    v_mfma_f32_32x32x16_bf16 v[112:127], v[72:75], v[64:67], v[112:127]
    v_subrev_u32 v8, 0x10000, v8
    v_subrev_u32 v9, 0x10000, v9
    v_subrev_u32 v10, 0x10000, v10
    v_subrev_u32 v11, 0x10000, v11
    ds_read_b64_tr_b16 v[24:25], v12 offset:0
    ds_read_b64_tr_b16 v[26:27], v12 offset:512
    ds_read_b128 v[16:19], v8 offset:0
    ds_read_b128 v[20:23], v8 offset:4096
    ds_read_b64_tr_b16 v[36:37], v12 offset:2048
    ds_read_b64_tr_b16 v[38:39], v12 offset:2560
    ds_read_b128 v[28:31], v9 offset:0
    v_mfma_f32_32x32x16_bf16 v[128:143], v[72:75], v[68:71], v[128:143]
    ds_read_b128 v[32:35], v9 offset:4096
    ds_read_b64_tr_b16 v[48:49], v12 offset:4096
    ds_read_b64_tr_b16 v[50:51], v12 offset:4608
    ds_read_b128 v[40:43], v10 offset:0
    ds_read_b128 v[44:47], v10 offset:4096
    s_waitcnt lgkmcnt(8)
    ds_read_b64_tr_b16 v[60:61], v12 offset:6144
    ds_read_b64_tr_b16 v[62:63], v12 offset:6656
    v_mfma_f32_32x32x16_bf16 v[144:159], v[64:67], v[76:79], v[144:159]
    ds_read_b128 v[52:55], v11 offset:0
    ds_read_b128 v[56:59], v11 offset:4096
    v_mfma_f32_32x32x16_bf16 v[160:175], v[68:71], v[76:79], v[160:175]
    v_mfma_f32_32x32x16_bf16 v[112:127], v[88:91], v[80:83], v[112:127]
    v_mfma_f32_32x32x16_bf16 v[128:143], v[88:91], v[84:87], v[128:143]
    v_mfma_f32_32x32x16_bf16 v[144:159], v[80:83], v[92:95], v[144:159]
    v_mfma_f32_32x32x16_bf16 v[160:175], v[84:87], v[92:95], v[160:175]
    s_nop 8
    v_cvt_pk_bf16_f32 v208, v112, v113
    v_cvt_pk_bf16_f32 v209, v114, v115
    v_cvt_pk_bf16_f32 v210, v116, v117
    v_cvt_pk_bf16_f32 v211, v118, v119
    s_add_u32 s28, s52, 0x200000
    buffer_store_dwordx4 v[208:211], v2, s[24:27], s28 offen offset:0 sc1
    v_cvt_pk_bf16_f32 v212, v120, v121
    v_cvt_pk_bf16_f32 v213, v122, v123
    v_cvt_pk_bf16_f32 v214, v124, v125
    v_cvt_pk_bf16_f32 v215, v126, v127
    s_add_u32 s28, s52, 0x210000
    buffer_store_dwordx4 v[212:215], v2, s[24:27], s28 offen offset:0 sc1
    v_cvt_pk_bf16_f32 v224, v144, v145
    v_cvt_pk_bf16_f32 v225, v146, v147
    v_cvt_pk_bf16_f32 v226, v148, v149
    v_cvt_pk_bf16_f32 v227, v150, v151
    s_add_u32 s28, s52, 0x3f0000
    buffer_store_dwordx4 v[224:227], v3, s[24:27], s28 offen offset:0 sc1
    v_cvt_pk_bf16_f32 v228, v152, v153
    v_cvt_pk_bf16_f32 v229, v154, v155
    v_cvt_pk_bf16_f32 v230, v156, v157
    v_cvt_pk_bf16_f32 v231, v158, v159
    s_add_u32 s28, s52, 0x3f0000
    buffer_store_dwordx4 v[228:231], v3, s[24:27], s28 offen offset:512 sc1
    v_cvt_pk_bf16_f32 v216, v128, v129
    v_cvt_pk_bf16_f32 v217, v130, v131
    v_cvt_pk_bf16_f32 v218, v132, v133
    v_cvt_pk_bf16_f32 v219, v134, v135
    s_add_u32 s28, s52, 0x200000
    buffer_store_dwordx4 v[216:219], v2, s[24:27], s28 offen offset:1024 sc1
    v_cvt_pk_bf16_f32 v220, v136, v137
    v_cvt_pk_bf16_f32 v221, v138, v139
    v_cvt_pk_bf16_f32 v222, v140, v141
    v_cvt_pk_bf16_f32 v223, v142, v143
    s_add_u32 s28, s52, 0x210000
    buffer_store_dwordx4 v[220:223], v2, s[24:27], s28 offen offset:1024 sc1
    v_cvt_pk_bf16_f32 v232, v160, v161
    v_cvt_pk_bf16_f32 v233, v162, v163
    v_cvt_pk_bf16_f32 v234, v164, v165
    v_cvt_pk_bf16_f32 v235, v166, v167
    s_add_u32 s28, s52, 0x3f0000
    buffer_store_dwordx4 v[232:235], v3, s[24:27], s28 offen offset:1024 sc1
    v_cvt_pk_bf16_f32 v236, v168, v169
    v_cvt_pk_bf16_f32 v237, v170, v171
    v_cvt_pk_bf16_f32 v238, v172, v173
    v_cvt_pk_bf16_f32 v239, v174, v175
    s_add_u32 s28, s52, 0x3f0000
    buffer_store_dwordx4 v[236:239], v3, s[24:27], s28 offen offset:1536 sc1
    s_waitcnt lgkmcnt(0)
    s_barrier
    v_mfma_f32_32x32x16_bf16 v[176:191], v[24:27], v[16:19], v[176:191]
    ds_read_b64_tr_b16 v[72:73], v12 offset:8192
    ds_read_b64_tr_b16 v[74:75], v12 offset:8704
    ds_read_b128 v[64:67], v8 offset:16384
    ds_read_b128 v[68:71], v8 offset:20480
    ds_read_b64_tr_b16 v[84:85], v12 offset:10240
    ds_read_b64_tr_b16 v[86:87], v12 offset:10752
    ds_read_b128 v[76:79], v9 offset:16384
    ds_read_b128 v[80:83], v9 offset:20480
    v_mfma_f32_32x32x16_bf16 v[192:207], v[24:27], v[20:23], v[192:207]
    ds_read_b64_tr_b16 v[96:97], v12 offset:12288
    ds_read_b64_tr_b16 v[98:99], v12 offset:12800
    ds_read_b128 v[88:91], v10 offset:16384
    ds_read_b128 v[92:95], v10 offset:20480
    s_waitcnt lgkmcnt(8)
    ds_read_b64_tr_b16 v[108:109], v12 offset:14336
    ds_read_b64_tr_b16 v[110:111], v12 offset:14848
    ds_read_b128 v[100:103], v11 offset:16384
    v_mfma_f32_32x32x16_bf16 v[176:191], v[36:39], v[28:31], v[176:191]
    ds_read_b128 v[104:107], v11 offset:20480
    v_mfma_f32_32x32x16_bf16 v[192:207], v[36:39], v[32:35], v[192:207]
    v_mfma_f32_32x32x16_bf16 v[176:191], v[48:51], v[40:43], v[176:191]
    v_mfma_f32_32x32x16_bf16 v[192:207], v[48:51], v[44:47], v[192:207]
    v_mfma_f32_32x32x16_bf16 v[176:191], v[60:63], v[52:55], v[176:191]
    v_mfma_f32_32x32x16_bf16 v[192:207], v[60:63], v[56:59], v[192:207]
    s_waitcnt lgkmcnt(0)
    s_barrier
    v_mfma_f32_32x32x16_bf16 v[176:191], v[72:75], v[64:67], v[176:191]
    ds_read_b64_tr_b16 v[24:25], v12 offset:16384
    ds_read_b64_tr_b16 v[26:27], v12 offset:16896
    ds_read_b128 v[16:19], v8 offset:32768
    ds_read_b128 v[20:23], v8 offset:36864
    ds_read_b64_tr_b16 v[36:37], v12 offset:18432
    ds_read_b64_tr_b16 v[38:39], v12 offset:18944
    ds_read_b128 v[28:31], v9 offset:32768
    ds_read_b128 v[32:35], v9 offset:36864
    v_mfma_f32_32x32x16_bf16 v[192:207], v[72:75], v[68:71], v[192:207]
    ds_read_b64_tr_b16 v[48:49], v12 offset:20480
    ds_read_b64_tr_b16 v[50:51], v12 offset:20992
    ds_read_b128 v[40:43], v10 offset:32768
    ds_read_b128 v[44:47], v10 offset:36864
    s_waitcnt lgkmcnt(8)
    ds_read_b64_tr_b16 v[60:61], v12 offset:22528
    ds_read_b64_tr_b16 v[62:63], v12 offset:23040
    ds_read_b128 v[52:55], v11 offset:32768
    v_mfma_f32_32x32x16_bf16 v[176:191], v[84:87], v[76:79], v[176:191]
    ds_read_b128 v[56:59], v11 offset:36864
    v_mfma_f32_32x32x16_bf16 v[192:207], v[84:87], v[80:83], v[192:207]
    v_mfma_f32_32x32x16_bf16 v[176:191], v[96:99], v[88:91], v[176:191]
    v_mfma_f32_32x32x16_bf16 v[192:207], v[96:99], v[92:95], v[192:207]
    v_mfma_f32_32x32x16_bf16 v[176:191], v[108:111], v[100:103], v[176:191]
    v_mfma_f32_32x32x16_bf16 v[192:207], v[108:111], v[104:107], v[192:207]
    s_waitcnt vmcnt(0) lgkmcnt(0)
    s_barrier
    v_mfma_f32_32x32x16_bf16 v[176:191], v[24:27], v[16:19], v[176:191]
    s_cmp_lg_u32 s33, 0
    s_cbranch_scc1 L_nosig_y
    s_mov_b32 s32, 65536
L_gettag_y:
    v_min_u32 v242, v240, v241
    v_cmp_ne_u32 vcc, 0, v242
    s_cbranch_vccnz L_havetag_y
    s_sub_u32 s32, s32, 1
    s_cbranch_scc1 L_havetag_y
    buffer_load_dwordx2 v[240:241], v13, s[4:7], 0 offen sc1
    s_waitcnt vmcnt(0)
    s_branch L_gettag_y
L_havetag_y:
    v_lshlrev_b32 v242, 14, v0
    s_lshl_b32 s28, s66, 11
    s_lshl_b32 s29, s67, 3
    s_add_u32 s28, s28, s29
    s_add_u32 s28, s28, 0xa40080
    s_mov_b32 exec_hi, 0
    buffer_store_dwordx2 v[240:241], v242, s[24:27], s28 offen sc1
    s_mov_b64 exec, -1
    ds_write_b64 v13, v[240:241] offset:0
L_nosig_y:
    ds_read_b64_tr_b16 v[72:73], v12 offset:24576
    ds_read_b64_tr_b16 v[74:75], v12 offset:25088
    ds_read_b128 v[64:67], v8 offset:49152
    ds_read_b128 v[68:71], v8 offset:53248
    ds_read_b64_tr_b16 v[84:85], v12 offset:26624
    ds_read_b64_tr_b16 v[86:87], v12 offset:27136
    ds_read_b128 v[76:79], v9 offset:49152
    v_mfma_f32_32x32x16_bf16 v[192:207], v[24:27], v[20:23], v[192:207]
    ds_read_b128 v[80:83], v9 offset:53248
    ds_read_b64_tr_b16 v[96:97], v12 offset:28672
    ds_read_b64_tr_b16 v[98:99], v12 offset:29184
    ds_read_b128 v[88:91], v10 offset:49152
    ds_read_b128 v[92:95], v10 offset:53248
    s_waitcnt lgkmcnt(8)
    ds_read_b64_tr_b16 v[108:109], v12 offset:30720
    ds_read_b64_tr_b16 v[110:111], v12 offset:31232
    v_mfma_f32_32x32x16_bf16 v[176:191], v[36:39], v[28:31], v[176:191]
    ds_read_b128 v[100:103], v11 offset:49152
    ds_read_b128 v[104:107], v11 offset:53248
    v_mfma_f32_32x32x16_bf16 v[192:207], v[36:39], v[32:35], v[192:207]
    v_mfma_f32_32x32x16_bf16 v[176:191], v[48:51], v[40:43], v[176:191]
    v_mfma_f32_32x32x16_bf16 v[192:207], v[48:51], v[44:47], v[192:207]
    v_mfma_f32_32x32x16_bf16 v[176:191], v[60:63], v[52:55], v[176:191]
    v_mfma_f32_32x32x16_bf16 v[192:207], v[60:63], v[56:59], v[192:207]
    s_waitcnt lgkmcnt(0)
    s_barrier
    v_mfma_f32_32x32x16_bf16 v[176:191], v[72:75], v[64:67], v[176:191]
    v_add_u32 v8, 0x10000, v8
    v_add_u32 v9, 0x10000, v9
    v_add_u32 v10, 0x10000, v10
    v_add_u32 v11, 0x10000, v11
    ds_read_b64_tr_b16 v[24:25], v12 offset:0
    ds_read_b64_tr_b16 v[26:27], v12 offset:512
    ds_read_b128 v[16:19], v8 offset:0
    ds_read_b128 v[20:23], v8 offset:4096
    ds_read_b64_tr_b16 v[36:37], v12 offset:2048
    ds_read_b64_tr_b16 v[38:39], v12 offset:2560
    ds_read_b128 v[28:31], v9 offset:0
    v_mfma_f32_32x32x16_bf16 v[192:207], v[72:75], v[68:71], v[192:207]
    ds_read_b128 v[32:35], v9 offset:4096
    ds_read_b64_tr_b16 v[48:49], v12 offset:4096
    ds_read_b64_tr_b16 v[50:51], v12 offset:4608
    ds_read_b128 v[40:43], v10 offset:0
    ds_read_b128 v[44:47], v10 offset:4096
    s_waitcnt lgkmcnt(8)
    ds_read_b64_tr_b16 v[60:61], v12 offset:6144
    ds_read_b64_tr_b16 v[62:63], v12 offset:6656
    v_mfma_f32_32x32x16_bf16 v[176:191], v[84:87], v[76:79], v[176:191]
    ds_read_b128 v[52:55], v11 offset:0
    ds_read_b128 v[56:59], v11 offset:4096
    ds_read_b64 v[244:245], v13 offset:0
    v_mfma_f32_32x32x16_bf16 v[192:207], v[84:87], v[80:83], v[192:207]
    v_mfma_f32_32x32x16_bf16 v[176:191], v[96:99], v[88:91], v[176:191]
    v_mfma_f32_32x32x16_bf16 v[192:207], v[96:99], v[92:95], v[192:207]
    v_mfma_f32_32x32x16_bf16 v[176:191], v[108:111], v[100:103], v[176:191]
    v_mfma_f32_32x32x16_bf16 v[192:207], v[108:111], v[104:107], v[192:207]
    s_waitcnt lgkmcnt(0)
    s_barrier
    v_mfma_f32_32x32x16_bf16 v[176:191], v[24:27], v[16:19], v[176:191]
    ds_read_b64_tr_b16 v[72:73], v12 offset:8192
    ds_read_b64_tr_b16 v[74:75], v12 offset:8704
    ds_read_b128 v[64:67], v8 offset:16384
    ds_read_b128 v[68:71], v8 offset:20480
    ds_read_b64_tr_b16 v[84:85], v12 offset:10240
    ds_read_b64_tr_b16 v[86:87], v12 offset:10752
    ds_read_b128 v[76:79], v9 offset:16384
    ds_read_b128 v[80:83], v9 offset:20480
    v_mfma_f32_32x32x16_bf16 v[192:207], v[24:27], v[20:23], v[192:207]
    ds_read_b64_tr_b16 v[96:97], v12 offset:12288
    ds_read_b64_tr_b16 v[98:99], v12 offset:12800
    ds_read_b128 v[88:91], v10 offset:16384
    ds_read_b128 v[92:95], v10 offset:20480
    s_waitcnt lgkmcnt(8)
    ds_read_b64_tr_b16 v[108:109], v12 offset:14336
    ds_read_b64_tr_b16 v[110:111], v12 offset:14848
    ds_read_b128 v[100:103], v11 offset:16384
    v_mfma_f32_32x32x16_bf16 v[176:191], v[36:39], v[28:31], v[176:191]
    ds_read_b128 v[104:107], v11 offset:20480
    v_readfirstlane_b32 s56, v244
    v_readfirstlane_b32 s57, v245
    v_mfma_f32_32x32x16_bf16 v[192:207], v[36:39], v[32:35], v[192:207]
    v_mfma_f32_32x32x16_bf16 v[176:191], v[48:51], v[40:43], v[176:191]
    v_mfma_f32_32x32x16_bf16 v[192:207], v[48:51], v[44:47], v[192:207]
    v_mfma_f32_32x32x16_bf16 v[176:191], v[60:63], v[52:55], v[176:191]
    v_mfma_f32_32x32x16_bf16 v[192:207], v[60:63], v[56:59], v[192:207]
    s_waitcnt lgkmcnt(0)
    s_barrier
    v_mfma_f32_32x32x16_bf16 v[176:191], v[72:75], v[64:67], v[176:191]
    ds_read_b64_tr_b16 v[24:25], v12 offset:16384
    ds_read_b64_tr_b16 v[26:27], v12 offset:16896
    ds_read_b128 v[16:19], v8 offset:32768
    ds_read_b128 v[20:23], v8 offset:36864
    ds_read_b64_tr_b16 v[36:37], v12 offset:18432
    ds_read_b64_tr_b16 v[38:39], v12 offset:18944
    ds_read_b128 v[28:31], v9 offset:32768
    ds_read_b128 v[32:35], v9 offset:36864
    v_mfma_f32_32x32x16_bf16 v[192:207], v[72:75], v[68:71], v[192:207]
    ds_read_b64_tr_b16 v[48:49], v12 offset:20480
    ds_read_b64_tr_b16 v[50:51], v12 offset:20992
    ds_read_b128 v[40:43], v10 offset:32768
    ds_read_b128 v[44:47], v10 offset:36864
    s_waitcnt lgkmcnt(8)
    ds_read_b64_tr_b16 v[60:61], v12 offset:22528
    ds_read_b64_tr_b16 v[62:63], v12 offset:23040
    ds_read_b128 v[52:55], v11 offset:32768
    v_mfma_f32_32x32x16_bf16 v[176:191], v[84:87], v[76:79], v[176:191]
    ds_read_b128 v[56:59], v11 offset:36864
    v_mfma_f32_32x32x16_bf16 v[192:207], v[84:87], v[80:83], v[192:207]
    v_mfma_f32_32x32x16_bf16 v[176:191], v[96:99], v[88:91], v[176:191]
    v_mfma_f32_32x32x16_bf16 v[192:207], v[96:99], v[92:95], v[192:207]
    v_mfma_f32_32x32x16_bf16 v[176:191], v[108:111], v[100:103], v[176:191]
    v_mfma_f32_32x32x16_bf16 v[192:207], v[108:111], v[104:107], v[192:207]
    s_waitcnt lgkmcnt(0)
    s_barrier
    v_mfma_f32_32x32x16_bf16 v[176:191], v[24:27], v[16:19], v[176:191]
    ds_read_b64_tr_b16 v[72:73], v12 offset:24576
    ds_read_b64_tr_b16 v[74:75], v12 offset:25088
    ds_read_b128 v[64:67], v8 offset:49152
    ds_read_b128 v[68:71], v8 offset:53248
    ds_read_b64_tr_b16 v[84:85], v12 offset:26624
    ds_read_b64_tr_b16 v[86:87], v12 offset:27136
    ds_read_b128 v[76:79], v9 offset:49152
    ds_read_b128 v[80:83], v9 offset:53248
    v_mfma_f32_32x32x16_bf16 v[192:207], v[24:27], v[20:23], v[192:207]
    ds_read_b64_tr_b16 v[96:97], v12 offset:28672
    ds_read_b64_tr_b16 v[98:99], v12 offset:29184
    ds_read_b128 v[88:91], v10 offset:49152
    ds_read_b128 v[92:95], v10 offset:53248
    s_waitcnt lgkmcnt(8)
    ds_read_b64_tr_b16 v[108:109], v12 offset:30720
    ds_read_b64_tr_b16 v[110:111], v12 offset:31232
    ds_read_b128 v[100:103], v11 offset:49152
    v_mfma_f32_32x32x16_bf16 v[176:191], v[36:39], v[28:31], v[176:191]
    ds_read_b128 v[104:107], v11 offset:53248
    v_mfma_f32_32x32x16_bf16 v[192:207], v[36:39], v[32:35], v[192:207]
    v_mfma_f32_32x32x16_bf16 v[176:191], v[48:51], v[40:43], v[176:191]
    v_mfma_f32_32x32x16_bf16 v[192:207], v[48:51], v[44:47], v[192:207]
    v_mfma_f32_32x32x16_bf16 v[176:191], v[60:63], v[52:55], v[176:191]
    v_mfma_f32_32x32x16_bf16 v[192:207], v[60:63], v[56:59], v[192:207]
    s_waitcnt lgkmcnt(0)
    v_mfma_f32_32x32x16_bf16 v[176:191], v[72:75], v[64:67], v[176:191]
    v_mfma_f32_32x32x16_bf16 v[192:207], v[72:75], v[68:71], v[192:207]
    v_mfma_f32_32x32x16_bf16 v[176:191], v[84:87], v[76:79], v[176:191]
    v_mfma_f32_32x32x16_bf16 v[192:207], v[84:87], v[80:83], v[192:207]
    v_mfma_f32_32x32x16_bf16 v[176:191], v[96:99], v[88:91], v[176:191]
    v_mfma_f32_32x32x16_bf16 v[192:207], v[96:99], v[92:95], v[192:207]
    v_mfma_f32_32x32x16_bf16 v[176:191], v[108:111], v[100:103], v[176:191]
    v_mfma_f32_32x32x16_bf16 v[192:207], v[108:111], v[104:107], v[192:207]
    v_mov_b32 v32, 0xb5c1a2a0
    s_mov_b32 s62, 0x3fb8aa3b
    s_mov_b32 s63, 0x3fb8aa3b
    s_xor_b32 s52, s52, 1048576
    s_nop 6
    v_pk_fma_f32 v[16:17], v[176:177], s[62:63], v[32:33] op_sel_hi:[1,1,0]
    v_pk_fma_f32 v[18:19], v[178:179], s[62:63], v[32:33] op_sel_hi:[1,1,0]
    v_exp_f32_e64 v16, v16 clamp
    v_exp_f32_e64 v17, v17 clamp
    v_exp_f32_e64 v18, v18 clamp
    v_exp_f32_e64 v19, v19 clamp
    v_max_f32 v176, 0x358637bd, v176
    v_max_f32 v177, 0x358637bd, v177
    v_max_f32 v178, 0x358637bd, v178
    v_max_f32 v179, 0x358637bd, v179
    v_pk_add_f32 v[176:177], v[176:177], v[16:17]
    v_pk_add_f32 v[178:179], v[178:179], v[18:19]
    v_pk_fma_f32 v[20:21], v[180:181], s[62:63], v[32:33] op_sel_hi:[1,1,0]
    v_pk_fma_f32 v[22:23], v[182:183], s[62:63], v[32:33] op_sel_hi:[1,1,0]
    v_exp_f32_e64 v20, v20 clamp
    v_exp_f32_e64 v21, v21 clamp
    v_exp_f32_e64 v22, v22 clamp
    v_exp_f32_e64 v23, v23 clamp
    v_max_f32 v180, 0x358637bd, v180
    v_max_f32 v181, 0x358637bd, v181
    v_max_f32 v182, 0x358637bd, v182
    v_max_f32 v183, 0x358637bd, v183
    v_pk_add_f32 v[180:181], v[180:181], v[20:21]
    v_pk_add_f32 v[182:183], v[182:183], v[22:23]
    v_pk_fma_f32 v[24:25], v[184:185], s[62:63], v[32:33] op_sel_hi:[1,1,0]
    v_pk_fma_f32 v[26:27], v[186:187], s[62:63], v[32:33] op_sel_hi:[1,1,0]
    v_exp_f32_e64 v24, v24 clamp
    v_exp_f32_e64 v25, v25 clamp
    v_exp_f32_e64 v26, v26 clamp
    v_exp_f32_e64 v27, v27 clamp
    v_max_f32 v184, 0x358637bd, v184
    v_max_f32 v185, 0x358637bd, v185
    v_max_f32 v186, 0x358637bd, v186
    v_max_f32 v187, 0x358637bd, v187
    v_pk_add_f32 v[184:185], v[184:185], v[24:25]
    v_pk_add_f32 v[186:187], v[186:187], v[26:27]
    v_pk_fma_f32 v[28:29], v[188:189], s[62:63], v[32:33] op_sel_hi:[1,1,0]
    v_pk_fma_f32 v[30:31], v[190:191], s[62:63], v[32:33] op_sel_hi:[1,1,0]
    v_exp_f32_e64 v28, v28 clamp
    v_exp_f32_e64 v29, v29 clamp
    v_exp_f32_e64 v30, v30 clamp
    v_exp_f32_e64 v31, v31 clamp
    v_max_f32 v188, 0x358637bd, v188
    v_max_f32 v189, 0x358637bd, v189
    v_max_f32 v190, 0x358637bd, v190
    v_max_f32 v191, 0x358637bd, v191
    v_pk_add_f32 v[188:189], v[188:189], v[28:29]
    v_pk_add_f32 v[190:191], v[190:191], v[30:31]
    v_cvt_pk_bf16_f32 v240, v176, v177
    v_cvt_pk_bf16_f32 v241, v178, v179
    v_cvt_pk_bf16_f32 v242, v180, v181
    v_cvt_pk_bf16_f32 v243, v182, v183
    v_cvt_pk_bf16_f32 v244, v184, v185
    v_cvt_pk_bf16_f32 v245, v186, v187
    v_cvt_pk_bf16_f32 v246, v188, v189
    v_cvt_pk_bf16_f32 v247, v190, v191
    v_pk_fma_f32 v[16:17], v[192:193], s[62:63], v[32:33] op_sel_hi:[1,1,0]
    v_pk_fma_f32 v[18:19], v[194:195], s[62:63], v[32:33] op_sel_hi:[1,1,0]
    v_exp_f32_e64 v16, v16 clamp
    v_exp_f32_e64 v17, v17 clamp
    v_exp_f32_e64 v18, v18 clamp
    v_exp_f32_e64 v19, v19 clamp
    v_max_f32 v192, 0x358637bd, v192
    v_max_f32 v193, 0x358637bd, v193
    v_max_f32 v194, 0x358637bd, v194
    v_max_f32 v195, 0x358637bd, v195
    v_pk_add_f32 v[192:193], v[192:193], v[16:17]
    v_pk_add_f32 v[194:195], v[194:195], v[18:19]
    v_pk_fma_f32 v[20:21], v[196:197], s[62:63], v[32:33] op_sel_hi:[1,1,0]
    v_pk_fma_f32 v[22:23], v[198:199], s[62:63], v[32:33] op_sel_hi:[1,1,0]
    v_exp_f32_e64 v20, v20 clamp
    v_exp_f32_e64 v21, v21 clamp
    v_exp_f32_e64 v22, v22 clamp
    v_exp_f32_e64 v23, v23 clamp
    v_max_f32 v196, 0x358637bd, v196
    v_max_f32 v197, 0x358637bd, v197
    v_max_f32 v198, 0x358637bd, v198
    v_max_f32 v199, 0x358637bd, v199
    v_pk_add_f32 v[196:197], v[196:197], v[20:21]
    v_pk_add_f32 v[198:199], v[198:199], v[22:23]
    v_pk_fma_f32 v[24:25], v[200:201], s[62:63], v[32:33] op_sel_hi:[1,1,0]
    v_pk_fma_f32 v[26:27], v[202:203], s[62:63], v[32:33] op_sel_hi:[1,1,0]
    v_exp_f32_e64 v24, v24 clamp
    v_exp_f32_e64 v25, v25 clamp
    v_exp_f32_e64 v26, v26 clamp
    v_exp_f32_e64 v27, v27 clamp
    v_max_f32 v200, 0x358637bd, v200
    v_max_f32 v201, 0x358637bd, v201
    v_max_f32 v202, 0x358637bd, v202
    v_max_f32 v203, 0x358637bd, v203
    v_pk_add_f32 v[200:201], v[200:201], v[24:25]
    v_pk_add_f32 v[202:203], v[202:203], v[26:27]
    v_pk_fma_f32 v[28:29], v[204:205], s[62:63], v[32:33] op_sel_hi:[1,1,0]
    v_pk_fma_f32 v[30:31], v[206:207], s[62:63], v[32:33] op_sel_hi:[1,1,0]
    v_exp_f32_e64 v28, v28 clamp
    v_exp_f32_e64 v29, v29 clamp
    v_exp_f32_e64 v30, v30 clamp
    v_exp_f32_e64 v31, v31 clamp
    v_max_f32 v204, 0x358637bd, v204
    v_max_f32 v205, 0x358637bd, v205
    v_max_f32 v206, 0x358637bd, v206
    v_max_f32 v207, 0x358637bd, v207
    v_pk_add_f32 v[204:205], v[204:205], v[28:29]
    v_pk_add_f32 v[206:207], v[206:207], v[30:31]
    v_cvt_pk_bf16_f32 v248, v192, v193
    v_cvt_pk_bf16_f32 v249, v194, v195
    v_cvt_pk_bf16_f32 v250, v196, v197
    v_cvt_pk_bf16_f32 v251, v198, v199
    v_cvt_pk_bf16_f32 v252, v200, v201
    v_cvt_pk_bf16_f32 v253, v202, v203
    v_cvt_pk_bf16_f32 v254, v204, v205
    v_cvt_pk_bf16_f32 v255, v206, v207
    v_mov_b32 v226, 0
    v_mov_b32 v15, 0
    s_mov_b32 exec_lo, 0x110000
    s_mov_b32 exec_hi, 0x110000
    v_mov_b32 v15, 0x3f803f80
    s_mov_b64 exec, -1
    v_mov_b32 v45, 0xdddddddd
    v_mov_b32 v46, s56
    v_mov_b32 v47, s57
    v_mov_b32 v24, v15
    v_mov_b32 v25, v15
    v_mov_b32 v26, v15
    v_mov_b32 v27, v15
    v_mov_b32 v28, v15
    v_mov_b32 v29, v15
    v_mov_b32 v30, v15
    v_mov_b32 v31, v15
    v_mov_b32 v32, v15
    v_mov_b32 v33, v15
    v_mov_b32 v34, v15
    v_mov_b32 v35, v15
L_attn:
    s_barrier
    s_add_u32 s28, s70, 49152
    v_add_u32 v9, s28, v1
    ds_read_b128 v[36:39], v9
    ds_read_b128 v[16:19], v1 offset:0
    ds_read_b128 v[20:23], v1 offset:1024
    s_mov_b64 exec, s[58:59]
    ds_read_b128 v[24:27], v4 offset:0
    ds_read_b128 v[28:31], v4 offset:512
    s_mov_b64 exec, -1
    s_waitcnt lgkmcnt(3)
    v_mfma_f32_32x32x16_bf16 v[48:63], v[16:19], v[36:39], 0
    v_mov_b32 v80, 0
    v_mov_b32 v81, 0
    v_mov_b32 v82, 0
    v_mov_b32 v83, 0
    v_mov_b32 v84, 0
    v_mov_b32 v85, 0
    v_mov_b32 v86, 0
    v_mov_b32 v87, 0
    v_mov_b32 v88, 0
    v_mov_b32 v89, 0
    v_mov_b32 v90, 0
    v_mov_b32 v91, 0
    v_mov_b32 v92, 0
    v_mov_b32 v93, 0
    v_mov_b32 v94, 0
    v_mov_b32 v95, 0
    v_exp_f32 v48, v48
    v_exp_f32 v49, v49
    s_setprio 3
    v_exp_f32 v50, v50
    v_exp_f32 v51, v51
    v_exp_f32 v52, v52
    v_exp_f32 v53, v53
    s_waitcnt lgkmcnt(0)
    v_mfma_f32_32x32x16_bf16 v[64:79], v[20:23], v[36:39], 0
    s_add_u32 m0, s70, 16384
    s_add_u32 s3, s78, 0x204000
    buffer_load_dwordx4 v1, s[24:27], s3 offen sc1 lds
    v_exp_f32 v54, v54
    v_exp_f32 v55, v55
    v_exp_f32 v56, v56
    v_exp_f32 v57, v57
    v_smfmac_f32_32x32x32_bf16 v[80:95], v[24:27], v[48:55], v45
    ds_read_b128 v[16:19], v1 offset:2048
    s_mov_b64 exec, s[58:59]
    ds_read_b128 v[24:27], v4 offset:1024
    ds_read_b128 v[32:35], v4 offset:1536
    s_mov_b64 exec, -1
    v_exp_f32 v58, v58
    v_exp_f32 v59, v59
    v_exp_f32 v60, v60
    v_exp_f32 v61, v61
    v_exp_f32 v62, v62
    v_exp_f32 v63, v63
    v_exp_f32 v64, v64
    v_exp_f32 v65, v65
    v_smfmac_f32_32x32x32_bf16 v[80:95], v[28:31], v[56:63], v45
    v_exp_f32 v66, v66
    v_exp_f32 v67, v67
    v_exp_f32 v68, v68
    v_exp_f32 v69, v69
    s_waitcnt lgkmcnt(0)
    v_mfma_f32_32x32x16_bf16 v[48:63], v[16:19], v[36:39], 0
    s_add_u32 m0, s70, 81920
    s_add_u32 s3, s78, 0x404000
    buffer_load_dwordx4 v1, s[24:27], s3 offen sc1 lds
    v_exp_f32 v70, v70
    v_exp_f32 v71, v71
    v_exp_f32 v72, v72
    v_exp_f32 v73, v73
    v_smfmac_f32_32x32x32_bf16 v[80:95], v[24:27], v[64:71], v45
    ds_read_b128 v[20:23], v1 offset:3072
    s_mov_b64 exec, s[58:59]
    ds_read_b128 v[24:27], v4 offset:2048
    ds_read_b128 v[28:31], v4 offset:2560
    s_mov_b64 exec, -1
    v_exp_f32 v74, v74
    v_exp_f32 v75, v75
    v_exp_f32 v76, v76
    v_exp_f32 v77, v77
    v_exp_f32 v78, v78
    v_exp_f32 v79, v79
    v_exp_f32 v48, v48
    v_exp_f32 v49, v49
    v_smfmac_f32_32x32x32_bf16 v[80:95], v[32:35], v[72:79], v45
    v_exp_f32 v50, v50
    v_exp_f32 v51, v51
    v_exp_f32 v52, v52
    v_exp_f32 v53, v53
    s_waitcnt lgkmcnt(0)
    v_mfma_f32_32x32x16_bf16 v[64:79], v[20:23], v[36:39], 0
    s_add_u32 m0, s70, 24576
    s_add_u32 s3, s78, 0x206000
    buffer_load_dwordx4 v1, s[24:27], s3 offen sc1 lds
    v_exp_f32 v54, v54
    v_exp_f32 v55, v55
    v_exp_f32 v56, v56
    v_exp_f32 v57, v57
    v_smfmac_f32_32x32x32_bf16 v[80:95], v[24:27], v[48:55], v45
    s_cmp_lg_u32 s54, 2
    s_cbranch_scc1 L_nokvc0
    ds_read_b128 v[96:99], v8 offset:0
    ds_read_b128 v[100:103], v8 offset:1024
    ds_read_b128 v[104:107], v8 offset:2048
    ds_read_b128 v[108:111], v8 offset:3072
L_nokvc0:
    ds_read_b128 v[16:19], v1 offset:4096
    s_mov_b64 exec, s[58:59]
    ds_read_b128 v[24:27], v4 offset:3072
    ds_read_b128 v[32:35], v4 offset:3584
    s_mov_b64 exec, -1
    v_exp_f32 v58, v58
    v_exp_f32 v59, v59
    v_exp_f32 v60, v60
    v_exp_f32 v61, v61
    v_exp_f32 v62, v62
    v_exp_f32 v63, v63
    v_exp_f32 v64, v64
    v_exp_f32 v65, v65
    v_smfmac_f32_32x32x32_bf16 v[80:95], v[28:31], v[56:63], v45
    v_exp_f32 v66, v66
    v_exp_f32 v67, v67
    v_exp_f32 v68, v68
    v_exp_f32 v69, v69
    s_waitcnt lgkmcnt(0)
    v_mfma_f32_32x32x16_bf16 v[48:63], v[16:19], v[36:39], 0
    s_cmp_lg_u32 s54, 2
    s_cbranch_scc1 L_nokvc1
    v_pk_add_f32 v[240:241], v[240:241], v[96:97]
    v_pk_add_f32 v[242:243], v[242:243], v[98:99]
    v_pk_add_f32 v[244:245], v[244:245], v[100:101]
    v_pk_add_f32 v[246:247], v[246:247], v[102:103]
    v_pk_add_f32 v[248:249], v[248:249], v[104:105]
    v_pk_add_f32 v[250:251], v[250:251], v[106:107]
    v_pk_add_f32 v[252:253], v[252:253], v[108:109]
    v_pk_add_f32 v[254:255], v[254:255], v[110:111]
L_nokvc1:
    s_add_u32 m0, s70, 90112
    s_add_u32 s3, s78, 0x406000
    buffer_load_dwordx4 v1, s[24:27], s3 offen sc1 lds
    v_exp_f32 v70, v70
    v_exp_f32 v71, v71
    v_exp_f32 v72, v72
    v_exp_f32 v73, v73
    v_smfmac_f32_32x32x32_bf16 v[80:95], v[24:27], v[64:71], v45
    ds_read_b128 v[20:23], v1 offset:5120
    s_mov_b64 exec, s[58:59]
    ds_read_b128 v[24:27], v4 offset:4096
    ds_read_b128 v[28:31], v4 offset:4608
    s_mov_b64 exec, -1
    v_exp_f32 v74, v74
    v_exp_f32 v75, v75
    v_exp_f32 v76, v76
    v_exp_f32 v77, v77
    v_exp_f32 v78, v78
    v_exp_f32 v79, v79
    v_exp_f32 v48, v48
    v_exp_f32 v49, v49
    v_smfmac_f32_32x32x32_bf16 v[80:95], v[32:35], v[72:79], v45
    s_setprio 2
    v_exp_f32 v50, v50
    v_exp_f32 v51, v51
    v_exp_f32 v52, v52
    v_exp_f32 v53, v53
    s_waitcnt lgkmcnt(0)
    v_mfma_f32_32x32x16_bf16 v[64:79], v[20:23], v[36:39], 0
    s_add_u32 m0, s70, 32768
    s_add_u32 s3, s78, 0x208000
    buffer_load_dwordx4 v1, s[24:27], s3 offen sc1 lds
    v_exp_f32 v54, v54
    v_exp_f32 v55, v55
    v_exp_f32 v56, v56
    v_exp_f32 v57, v57
    v_smfmac_f32_32x32x32_bf16 v[80:95], v[24:27], v[48:55], v45
    ds_read_b128 v[16:19], v1 offset:6144
    s_mov_b64 exec, s[58:59]
    ds_read_b128 v[24:27], v4 offset:5120
    ds_read_b128 v[32:35], v4 offset:5632
    s_mov_b64 exec, -1
    v_exp_f32 v58, v58
    v_exp_f32 v59, v59
    v_exp_f32 v60, v60
    v_exp_f32 v61, v61
    v_exp_f32 v62, v62
    v_exp_f32 v63, v63
    v_exp_f32 v64, v64
    v_exp_f32 v65, v65
    v_smfmac_f32_32x32x32_bf16 v[80:95], v[28:31], v[56:63], v45
    s_setprio 1
    v_exp_f32 v66, v66
    v_exp_f32 v67, v67
    v_exp_f32 v68, v68
    v_exp_f32 v69, v69
    s_waitcnt lgkmcnt(0)
    v_mfma_f32_32x32x16_bf16 v[48:63], v[16:19], v[36:39], 0
    s_add_u32 m0, s70, 98304
    s_add_u32 s3, s78, 0x408000
    buffer_load_dwordx4 v1, s[24:27], s3 offen sc1 lds
    v_exp_f32 v70, v70
    v_exp_f32 v71, v71
    v_exp_f32 v72, v72
    v_exp_f32 v73, v73
    v_smfmac_f32_32x32x32_bf16 v[80:95], v[24:27], v[64:71], v45
    ds_read_b128 v[20:23], v1 offset:7168
    s_mov_b64 exec, s[58:59]
    ds_read_b128 v[24:27], v4 offset:6144
    ds_read_b128 v[28:31], v4 offset:6656
    s_mov_b64 exec, -1
    v_exp_f32 v74, v74
    v_exp_f32 v75, v75
    v_exp_f32 v76, v76
    v_exp_f32 v77, v77
    v_exp_f32 v78, v78
    v_exp_f32 v79, v79
    v_exp_f32 v48, v48
    v_exp_f32 v49, v49
    v_smfmac_f32_32x32x32_bf16 v[80:95], v[32:35], v[72:79], v45
    v_exp_f32 v50, v50
    v_exp_f32 v51, v51
    v_exp_f32 v52, v52
    v_exp_f32 v53, v53
    s_waitcnt lgkmcnt(0)
    v_mfma_f32_32x32x16_bf16 v[64:79], v[20:23], v[36:39], 0
    s_add_u32 m0, s70, 40960
    s_add_u32 s3, s78, 0x20a000
    buffer_load_dwordx4 v1, s[24:27], s3 offen sc1 lds
    v_exp_f32 v54, v54
    v_exp_f32 v55, v55
    v_exp_f32 v56, v56
    v_exp_f32 v57, v57
    v_smfmac_f32_32x32x32_bf16 v[80:95], v[24:27], v[48:55], v45
    s_waitcnt vmcnt(5)
    s_barrier
    ds_read_b128 v[16:19], v1 offset:8192
    s_mov_b64 exec, s[58:59]
    ds_read_b128 v[24:27], v4 offset:7168
    ds_read_b128 v[32:35], v4 offset:7680
    s_mov_b64 exec, -1
    v_exp_f32 v58, v58
    v_exp_f32 v59, v59
    v_exp_f32 v60, v60
    v_exp_f32 v61, v61
    v_exp_f32 v62, v62
    v_exp_f32 v63, v63
    v_exp_f32 v64, v64
    v_exp_f32 v65, v65
    v_smfmac_f32_32x32x32_bf16 v[80:95], v[28:31], v[56:63], v45
    s_setprio 3
    v_exp_f32 v66, v66
    v_exp_f32 v67, v67
    v_exp_f32 v68, v68
    v_exp_f32 v69, v69
    s_waitcnt lgkmcnt(0)
    v_mfma_f32_32x32x16_bf16 v[48:63], v[16:19], v[36:39], 0
    s_cmp_eq_u32 s54, 0
    s_cbranch_scc1 L_nolate0
    s_cmp_eq_u32 s54, 2
    s_cbranch_scc1 L_latekv0
    s_add_u32 s28, s52, 0x600000
    buffer_store_dwordx4 v[240:243], v1, s[24:27], s28 offen offset:0 sc1
    s_branch L_nolate0
L_latekv0:
    s_add_u32 s28, s55, 0x800000
    buffer_store_dwordx4 v[240:243], v1, s[24:27], s28 offen offset:0 sc1
L_nolate0:
    s_add_u32 m0, s70, 106496
    s_add_u32 s3, s78, 0x40a000
    buffer_load_dwordx4 v1, s[24:27], s3 offen sc1 lds
    v_exp_f32 v70, v70
    v_exp_f32 v71, v71
    v_exp_f32 v72, v72
    v_exp_f32 v73, v73
    v_smfmac_f32_32x32x32_bf16 v[80:95], v[24:27], v[64:71], v45
    ds_read_b128 v[20:23], v1 offset:9216
    s_mov_b64 exec, s[58:59]
    ds_read_b128 v[24:27], v4 offset:8192
    ds_read_b128 v[28:31], v4 offset:8704
    s_mov_b64 exec, -1
    v_exp_f32 v74, v74
    v_exp_f32 v75, v75
    v_exp_f32 v76, v76
    v_exp_f32 v77, v77
    v_exp_f32 v78, v78
    v_exp_f32 v79, v79
    v_exp_f32 v48, v48
    v_exp_f32 v49, v49
    v_smfmac_f32_32x32x32_bf16 v[80:95], v[32:35], v[72:79], v45
    v_exp_f32 v50, v50
    v_exp_f32 v51, v51
    v_exp_f32 v52, v52
    v_exp_f32 v53, v53
    s_waitcnt lgkmcnt(0)
    v_mfma_f32_32x32x16_bf16 v[64:79], v[20:23], v[36:39], 0
    s_cmp_eq_u32 s54, 0
    s_cbranch_scc1 L_nolate1
    s_cmp_eq_u32 s54, 2
    s_cbranch_scc1 L_latekv1
    s_add_u32 s28, s52, 0x610000
    buffer_store_dwordx4 v[244:247], v1, s[24:27], s28 offen offset:0 sc1
    s_branch L_nolate1
L_latekv1:
    s_add_u32 s28, s55, 0x800000
    buffer_store_dwordx4 v[244:247], v1, s[24:27], s28 offen offset:1024 sc1
L_nolate1:
    s_add_u32 m0, s70, 49152
    s_add_u32 s3, s78, 0x20c000
    buffer_load_dwordx4 v1, s[24:27], s3 offen sc1 lds
    v_exp_f32 v54, v54
    v_exp_f32 v55, v55
    v_exp_f32 v56, v56
    v_exp_f32 v57, v57
    v_smfmac_f32_32x32x32_bf16 v[80:95], v[24:27], v[48:55], v45
    ds_read_b128 v[16:19], v1 offset:10240
    s_mov_b64 exec, s[58:59]
    ds_read_b128 v[24:27], v4 offset:9216
    ds_read_b128 v[32:35], v4 offset:9728
    s_mov_b64 exec, -1
    v_exp_f32 v58, v58
    v_exp_f32 v59, v59
    v_exp_f32 v60, v60
    v_exp_f32 v61, v61
    v_exp_f32 v62, v62
    v_exp_f32 v63, v63
    v_exp_f32 v64, v64
    v_exp_f32 v65, v65
    v_smfmac_f32_32x32x32_bf16 v[80:95], v[28:31], v[56:63], v45
    v_exp_f32 v66, v66
    v_exp_f32 v67, v67
    v_exp_f32 v68, v68
    v_exp_f32 v69, v69
    s_waitcnt lgkmcnt(0)
    v_mfma_f32_32x32x16_bf16 v[48:63], v[16:19], v[36:39], 0
    s_cmp_eq_u32 s54, 0
    s_cbranch_scc1 L_nolate2
    s_cmp_eq_u32 s54, 2
    s_cbranch_scc1 L_latekv2
    s_add_u32 s28, s52, 0x600000
    buffer_store_dwordx4 v[248:251], v1, s[24:27], s28 offen offset:1024 sc1
    s_branch L_nolate2
L_latekv2:
    v_xor_b32 v9, 0x100, v1
    s_add_u32 s28, s55, 0x810000
    buffer_store_dwordx4 v[248:251], v9, s[24:27], s28 offen offset:0 sc1
L_nolate2:
    s_add_u32 m0, s70, 114688
    s_add_u32 s3, s78, 0x40c000
    buffer_load_dwordx4 v1, s[24:27], s3 offen sc1 lds
    v_exp_f32 v70, v70
    v_exp_f32 v71, v71
    v_exp_f32 v72, v72
    v_exp_f32 v73, v73
    v_smfmac_f32_32x32x32_bf16 v[80:95], v[24:27], v[64:71], v45
    ds_read_b128 v[20:23], v1 offset:11264
    s_mov_b64 exec, s[58:59]
    ds_read_b128 v[24:27], v4 offset:10240
    ds_read_b128 v[28:31], v4 offset:10752
    s_mov_b64 exec, -1
    v_exp_f32 v74, v74
    v_exp_f32 v75, v75
    v_exp_f32 v76, v76
    v_exp_f32 v77, v77
    v_exp_f32 v78, v78
    v_exp_f32 v79, v79
    v_exp_f32 v48, v48
    v_exp_f32 v49, v49
    v_smfmac_f32_32x32x32_bf16 v[80:95], v[32:35], v[72:79], v45
    v_exp_f32 v50, v50
    v_exp_f32 v51, v51
    v_exp_f32 v52, v52
    v_exp_f32 v53, v53
    s_waitcnt lgkmcnt(0)
    v_mfma_f32_32x32x16_bf16 v[64:79], v[20:23], v[36:39], 0
    s_cmp_eq_u32 s54, 0
    s_cbranch_scc1 L_nolate3
    s_cmp_eq_u32 s54, 2
    s_cbranch_scc1 L_latekv3
    s_add_u32 s28, s52, 0x610000
    buffer_store_dwordx4 v[252:255], v1, s[24:27], s28 offen offset:1024 sc1
    s_branch L_nolate3
L_latekv3:
    v_xor_b32 v9, 0x100, v1
    s_add_u32 s28, s55, 0x810000
    buffer_store_dwordx4 v[252:255], v9, s[24:27], s28 offen offset:1024 sc1
L_nolate3:
    s_add_u32 m0, s70, 57344
    s_add_u32 s3, s78, 0x20e000
    buffer_load_dwordx4 v1, s[24:27], s3 offen sc1 lds
    v_exp_f32 v54, v54
    v_exp_f32 v55, v55
    v_exp_f32 v56, v56
    v_exp_f32 v57, v57
    v_smfmac_f32_32x32x32_bf16 v[80:95], v[24:27], v[48:55], v45
    ds_read_b128 v[16:19], v1 offset:12288
    s_mov_b64 exec, s[58:59]
    ds_read_b128 v[24:27], v4 offset:11264
    ds_read_b128 v[32:35], v4 offset:11776
    s_mov_b64 exec, -1
    v_exp_f32 v58, v58
    v_exp_f32 v59, v59
    v_exp_f32 v60, v60
    v_exp_f32 v61, v61
    v_exp_f32 v62, v62
    v_exp_f32 v63, v63
    v_exp_f32 v64, v64
    v_exp_f32 v65, v65
    v_smfmac_f32_32x32x32_bf16 v[80:95], v[28:31], v[56:63], v45
    v_exp_f32 v66, v66
    v_exp_f32 v67, v67
    v_exp_f32 v68, v68
    v_exp_f32 v69, v69
    s_waitcnt lgkmcnt(0)
    v_mfma_f32_32x32x16_bf16 v[48:63], v[16:19], v[36:39], 0
    s_add_u32 m0, s70, 122880
    s_add_u32 s3, s78, 0x40e000
    buffer_load_dwordx4 v1, s[24:27], s3 offen sc1 lds
    v_exp_f32 v70, v70
    v_exp_f32 v71, v71
    v_exp_f32 v72, v72
    v_exp_f32 v73, v73
    v_smfmac_f32_32x32x32_bf16 v[80:95], v[24:27], v[64:71], v45
    ds_read_b128 v[20:23], v1 offset:13312
    s_mov_b64 exec, s[58:59]
    ds_read_b128 v[24:27], v4 offset:12288
    ds_read_b128 v[28:31], v4 offset:12800
    s_mov_b64 exec, -1
    v_exp_f32 v74, v74
    v_exp_f32 v75, v75
    v_exp_f32 v76, v76
    v_exp_f32 v77, v77
    v_exp_f32 v78, v78
    v_exp_f32 v79, v79
    v_exp_f32 v48, v48
    v_exp_f32 v49, v49
    v_smfmac_f32_32x32x32_bf16 v[80:95], v[32:35], v[72:79], v45
    s_setprio 2
    v_exp_f32 v50, v50
    v_exp_f32 v51, v51
    v_exp_f32 v52, v52
    v_exp_f32 v53, v53
    s_waitcnt lgkmcnt(0)
    v_mfma_f32_32x32x16_bf16 v[64:79], v[20:23], v[36:39], 0
    v_exp_f32 v54, v54
    v_exp_f32 v55, v55
    v_exp_f32 v56, v56
    v_exp_f32 v57, v57
    v_smfmac_f32_32x32x32_bf16 v[80:95], v[24:27], v[48:55], v45
    ds_read_b128 v[16:19], v1 offset:14336
    s_mov_b64 exec, s[58:59]
    ds_read_b128 v[24:27], v4 offset:13312
    ds_read_b128 v[32:35], v4 offset:13824
    s_mov_b64 exec, -1
    v_exp_f32 v58, v58
    v_exp_f32 v59, v59
    v_exp_f32 v60, v60
    v_exp_f32 v61, v61
    v_exp_f32 v62, v62
    v_exp_f32 v63, v63
    v_exp_f32 v64, v64
    v_exp_f32 v65, v65
    v_smfmac_f32_32x32x32_bf16 v[80:95], v[28:31], v[56:63], v45
    s_setprio 1
    v_exp_f32 v66, v66
    v_exp_f32 v67, v67
    v_exp_f32 v68, v68
    v_exp_f32 v69, v69
    s_waitcnt lgkmcnt(0)
    v_mfma_f32_32x32x16_bf16 v[48:63], v[16:19], v[36:39], 0
    v_exp_f32 v70, v70
    v_exp_f32 v71, v71
    v_exp_f32 v72, v72
    v_exp_f32 v73, v73
    v_smfmac_f32_32x32x32_bf16 v[80:95], v[24:27], v[64:71], v45
    ds_read_b128 v[20:23], v1 offset:15360
    s_mov_b64 exec, s[58:59]
    ds_read_b128 v[24:27], v4 offset:14336
    ds_read_b128 v[28:31], v4 offset:14848
    s_mov_b64 exec, -1
    v_exp_f32 v74, v74
    v_exp_f32 v75, v75
    v_exp_f32 v76, v76
    v_exp_f32 v77, v77
    v_exp_f32 v78, v78
    v_exp_f32 v79, v79
    v_exp_f32 v48, v48
    v_exp_f32 v49, v49
    v_smfmac_f32_32x32x32_bf16 v[80:95], v[32:35], v[72:79], v45
    v_exp_f32 v50, v50
    v_exp_f32 v51, v51
    v_exp_f32 v52, v52
    v_exp_f32 v53, v53
    s_waitcnt lgkmcnt(0)
    v_mfma_f32_32x32x16_bf16 v[64:79], v[20:23], v[36:39], 0
    v_exp_f32 v54, v54
    v_exp_f32 v55, v55
    v_exp_f32 v56, v56
    v_exp_f32 v57, v57
    v_smfmac_f32_32x32x32_bf16 v[80:95], v[24:27], v[48:55], v45
    s_waitcnt vmcnt(0)
    s_barrier
    s_cmp_lg_u32 s33, 4
    s_cbranch_scc1 L_nosig2
    s_mov_b32 exec_hi, 0
    buffer_store_dwordx2 v[46:47], v226, s[24:27], s55 offen offset:256 sc1
    v_lshlrev_b32 v8, 11, v0
    s_lshl_b32 s28, s64, 16
    s_lshl_b32 s29, s35, 3
    s_add_u32 s28, s28, s29
    s_add_u32 s28, s28, 0xa40200
    buffer_store_dwordx2 v[46:47], v8, s[24:27], s28 offen sc1
    s_mov_b64 exec, -1
L_nosig2:
    ds_read_b128 v[16:19], v1 offset:16384
    s_mov_b64 exec, s[58:59]
    ds_read_b128 v[24:27], v4 offset:15360
    ds_read_b128 v[32:35], v4 offset:15872
    s_mov_b64 exec, -1
    v_exp_f32 v58, v58
    v_exp_f32 v59, v59
    v_exp_f32 v60, v60
    v_exp_f32 v61, v61
    v_exp_f32 v62, v62
    v_exp_f32 v63, v63
    v_exp_f32 v64, v64
    v_exp_f32 v65, v65
    v_smfmac_f32_32x32x32_bf16 v[80:95], v[28:31], v[56:63], v45
    s_setprio 3
    v_exp_f32 v66, v66
    v_exp_f32 v67, v67
    v_exp_f32 v68, v68
    v_exp_f32 v69, v69
    s_waitcnt lgkmcnt(0)
    v_mfma_f32_32x32x16_bf16 v[48:63], v[16:19], v[36:39], 0
    v_lshlrev_b32 v8, 7, v0
    s_lshr_b32 s28, s2, 3
    s_lshl_b32 s28, s28, 3
    s_add_u32 s28, s28, s33
    s_lshl_b32 s28, s28, 11
    s_mov_b64 exec, 0xffff
    buffer_load_dword v227, v8, s[16:19], s28 offen
    buffer_load_dword v227, v8, s[12:15], s28 offen
    s_mov_b64 exec, -1
    v_exp_f32 v70, v70
    v_exp_f32 v71, v71
    v_exp_f32 v72, v72
    v_exp_f32 v73, v73
    v_smfmac_f32_32x32x32_bf16 v[80:95], v[24:27], v[64:71], v45
    ds_read_b128 v[20:23], v1 offset:17408
    s_mov_b64 exec, s[58:59]
    ds_read_b128 v[24:27], v4 offset:16384
    ds_read_b128 v[28:31], v4 offset:16896
    s_mov_b64 exec, -1
    v_exp_f32 v74, v74
    v_exp_f32 v75, v75
    v_exp_f32 v76, v76
    v_exp_f32 v77, v77
    v_exp_f32 v78, v78
    v_exp_f32 v79, v79
    v_exp_f32 v48, v48
    v_exp_f32 v49, v49
    v_smfmac_f32_32x32x32_bf16 v[80:95], v[32:35], v[72:79], v45
    v_exp_f32 v50, v50
    v_exp_f32 v51, v51
    v_exp_f32 v52, v52
    v_exp_f32 v53, v53
    s_waitcnt lgkmcnt(0)
    v_mfma_f32_32x32x16_bf16 v[64:79], v[20:23], v[36:39], 0
    v_exp_f32 v54, v54
    v_exp_f32 v55, v55
    v_exp_f32 v56, v56
    v_exp_f32 v57, v57
    v_smfmac_f32_32x32x32_bf16 v[80:95], v[24:27], v[48:55], v45
    ds_read_b128 v[16:19], v1 offset:18432
    s_mov_b64 exec, s[58:59]
    ds_read_b128 v[24:27], v4 offset:17408
    ds_read_b128 v[32:35], v4 offset:17920
    s_mov_b64 exec, -1
    v_exp_f32 v58, v58
    v_exp_f32 v59, v59
    v_exp_f32 v60, v60
    v_exp_f32 v61, v61
    v_exp_f32 v62, v62
    v_exp_f32 v63, v63
    v_exp_f32 v64, v64
    v_exp_f32 v65, v65
    v_smfmac_f32_32x32x32_bf16 v[80:95], v[28:31], v[56:63], v45
    v_exp_f32 v66, v66
    v_exp_f32 v67, v67
    v_exp_f32 v68, v68
    v_exp_f32 v69, v69
    s_waitcnt lgkmcnt(0)
    v_mfma_f32_32x32x16_bf16 v[48:63], v[16:19], v[36:39], 0
    v_exp_f32 v70, v70
    v_exp_f32 v71, v71
    v_exp_f32 v72, v72
    v_exp_f32 v73, v73
    v_smfmac_f32_32x32x32_bf16 v[80:95], v[24:27], v[64:71], v45
    ds_read_b128 v[20:23], v1 offset:19456
    s_mov_b64 exec, s[58:59]
    ds_read_b128 v[24:27], v4 offset:18432
    ds_read_b128 v[28:31], v4 offset:18944
    s_mov_b64 exec, -1
    v_exp_f32 v74, v74
    v_exp_f32 v75, v75
    v_exp_f32 v76, v76
    v_exp_f32 v77, v77
    v_exp_f32 v78, v78
    v_exp_f32 v79, v79
    v_exp_f32 v48, v48
    v_exp_f32 v49, v49
    v_smfmac_f32_32x32x32_bf16 v[80:95], v[32:35], v[72:79], v45
    v_exp_f32 v50, v50
    v_exp_f32 v51, v51
    v_exp_f32 v52, v52
    v_exp_f32 v53, v53
    s_waitcnt lgkmcnt(0)
    v_mfma_f32_32x32x16_bf16 v[64:79], v[20:23], v[36:39], 0
    v_exp_f32 v54, v54
    v_exp_f32 v55, v55
    v_exp_f32 v56, v56
    v_exp_f32 v57, v57
    v_smfmac_f32_32x32x32_bf16 v[80:95], v[24:27], v[48:55], v45
    ds_read_b128 v[16:19], v1 offset:20480
    s_mov_b64 exec, s[58:59]
    ds_read_b128 v[24:27], v4 offset:19456
    ds_read_b128 v[32:35], v4 offset:19968
    s_mov_b64 exec, -1
    v_exp_f32 v58, v58
    v_exp_f32 v59, v59
    v_exp_f32 v60, v60
    v_exp_f32 v61, v61
    v_exp_f32 v62, v62
    v_exp_f32 v63, v63
    v_exp_f32 v64, v64
    v_exp_f32 v65, v65
    v_smfmac_f32_32x32x32_bf16 v[80:95], v[28:31], v[56:63], v45
    v_exp_f32 v66, v66
    v_exp_f32 v67, v67
    v_exp_f32 v68, v68
    v_exp_f32 v69, v69
    s_waitcnt lgkmcnt(0)
    v_mfma_f32_32x32x16_bf16 v[48:63], v[16:19], v[36:39], 0
    v_exp_f32 v70, v70
    v_exp_f32 v71, v71
    v_exp_f32 v72, v72
    v_exp_f32 v73, v73
    v_smfmac_f32_32x32x32_bf16 v[80:95], v[24:27], v[64:71], v45
    ds_read_b128 v[20:23], v1 offset:21504
    s_mov_b64 exec, s[58:59]
    ds_read_b128 v[24:27], v4 offset:20480
    ds_read_b128 v[28:31], v4 offset:20992
    s_mov_b64 exec, -1
    v_exp_f32 v74, v74
    v_exp_f32 v75, v75
    v_exp_f32 v76, v76
    v_exp_f32 v77, v77
    v_exp_f32 v78, v78
    v_exp_f32 v79, v79
    v_exp_f32 v48, v48
    v_exp_f32 v49, v49
    v_smfmac_f32_32x32x32_bf16 v[80:95], v[32:35], v[72:79], v45
    v_exp_f32 v50, v50
    v_exp_f32 v51, v51
    v_exp_f32 v52, v52
    v_exp_f32 v53, v53
    s_waitcnt lgkmcnt(0)
    v_mfma_f32_32x32x16_bf16 v[64:79], v[20:23], v[36:39], 0
    v_exp_f32 v54, v54
    v_exp_f32 v55, v55
    v_exp_f32 v56, v56
    v_exp_f32 v57, v57
    v_smfmac_f32_32x32x32_bf16 v[80:95], v[24:27], v[48:55], v45
    ds_read_b128 v[16:19], v1 offset:22528
    s_mov_b64 exec, s[58:59]
    ds_read_b128 v[24:27], v4 offset:21504
    ds_read_b128 v[32:35], v4 offset:22016
    s_mov_b64 exec, -1
    v_exp_f32 v58, v58
    v_exp_f32 v59, v59
    v_exp_f32 v60, v60
    v_exp_f32 v61, v61
    v_exp_f32 v62, v62
    v_exp_f32 v63, v63
    v_exp_f32 v64, v64
    v_exp_f32 v65, v65
    v_smfmac_f32_32x32x32_bf16 v[80:95], v[28:31], v[56:63], v45
    v_exp_f32 v66, v66
    v_exp_f32 v67, v67
    v_exp_f32 v68, v68
    v_exp_f32 v69, v69
    s_waitcnt lgkmcnt(0)
    v_mfma_f32_32x32x16_bf16 v[48:63], v[16:19], v[36:39], 0
    v_exp_f32 v70, v70
    v_exp_f32 v71, v71
    v_exp_f32 v72, v72
    v_exp_f32 v73, v73
    v_smfmac_f32_32x32x32_bf16 v[80:95], v[24:27], v[64:71], v45
    ds_read_b128 v[20:23], v1 offset:23552
    s_mov_b64 exec, s[58:59]
    ds_read_b128 v[24:27], v4 offset:22528
    ds_read_b128 v[28:31], v4 offset:23040
    s_mov_b64 exec, -1
    v_exp_f32 v74, v74
    v_exp_f32 v75, v75
    v_exp_f32 v76, v76
    v_exp_f32 v77, v77
    v_exp_f32 v78, v78
    v_exp_f32 v79, v79
    v_exp_f32 v48, v48
    v_exp_f32 v49, v49
    v_smfmac_f32_32x32x32_bf16 v[80:95], v[32:35], v[72:79], v45
    v_exp_f32 v50, v50
    v_exp_f32 v51, v51
    v_exp_f32 v52, v52
    v_exp_f32 v53, v53
    s_waitcnt lgkmcnt(0)
    v_mfma_f32_32x32x16_bf16 v[64:79], v[20:23], v[36:39], 0
    v_lshlrev_b32 v10, 3, v0
    buffer_load_dwordx2 v[224:225], v10, s[24:27], s68 offen offset:256 sc1
    v_exp_f32 v54, v54
    v_exp_f32 v55, v55
    v_exp_f32 v56, v56
    v_exp_f32 v57, v57
    v_smfmac_f32_32x32x32_bf16 v[80:95], v[24:27], v[48:55], v45
    ds_read_b128 v[16:19], v1 offset:24576
    s_mov_b64 exec, s[58:59]
    ds_read_b128 v[24:27], v4 offset:23552
    ds_read_b128 v[32:35], v4 offset:24064
    s_mov_b64 exec, -1
    v_exp_f32 v58, v58
    v_exp_f32 v59, v59
    v_exp_f32 v60, v60
    v_exp_f32 v61, v61
    v_exp_f32 v62, v62
    v_exp_f32 v63, v63
    v_exp_f32 v64, v64
    v_exp_f32 v65, v65
    v_smfmac_f32_32x32x32_bf16 v[80:95], v[28:31], v[56:63], v45
    v_exp_f32 v66, v66
    v_exp_f32 v67, v67
    v_exp_f32 v68, v68
    v_exp_f32 v69, v69
    s_waitcnt lgkmcnt(0)
    v_mfma_f32_32x32x16_bf16 v[48:63], v[16:19], v[36:39], 0
    v_exp_f32 v70, v70
    v_exp_f32 v71, v71
    v_exp_f32 v72, v72
    v_exp_f32 v73, v73
    v_smfmac_f32_32x32x32_bf16 v[80:95], v[24:27], v[64:71], v45
    ds_read_b128 v[20:23], v1 offset:25600
    s_mov_b64 exec, s[58:59]
    ds_read_b128 v[24:27], v4 offset:24576
    ds_read_b128 v[28:31], v4 offset:25088
    s_mov_b64 exec, -1
    v_exp_f32 v74, v74
    v_exp_f32 v75, v75
    v_exp_f32 v76, v76
    v_exp_f32 v77, v77
    v_exp_f32 v78, v78
    v_exp_f32 v79, v79
    v_exp_f32 v48, v48
    v_exp_f32 v49, v49
    v_smfmac_f32_32x32x32_bf16 v[80:95], v[32:35], v[72:79], v45
    v_exp_f32 v50, v50
    v_exp_f32 v51, v51
    v_exp_f32 v52, v52
    v_exp_f32 v53, v53
    s_waitcnt lgkmcnt(0)
    v_mfma_f32_32x32x16_bf16 v[64:79], v[20:23], v[36:39], 0
    v_exp_f32 v54, v54
    v_exp_f32 v55, v55
    v_exp_f32 v56, v56
    v_exp_f32 v57, v57
    v_smfmac_f32_32x32x32_bf16 v[80:95], v[24:27], v[48:55], v45
    ds_read_b128 v[16:19], v1 offset:26624
    s_mov_b64 exec, s[58:59]
    ds_read_b128 v[24:27], v4 offset:25600
    ds_read_b128 v[32:35], v4 offset:26112
    s_mov_b64 exec, -1
    v_exp_f32 v58, v58
    v_exp_f32 v59, v59
    v_exp_f32 v60, v60
    v_exp_f32 v61, v61
    v_exp_f32 v62, v62
    v_exp_f32 v63, v63
    v_exp_f32 v64, v64
    v_exp_f32 v65, v65
    v_smfmac_f32_32x32x32_bf16 v[80:95], v[28:31], v[56:63], v45
    v_exp_f32 v66, v66
    v_exp_f32 v67, v67
    v_exp_f32 v68, v68
    v_exp_f32 v69, v69
    s_waitcnt lgkmcnt(0)
    v_mfma_f32_32x32x16_bf16 v[48:63], v[16:19], v[36:39], 0
    v_exp_f32 v70, v70
    v_exp_f32 v71, v71
    v_exp_f32 v72, v72
    v_exp_f32 v73, v73
    v_smfmac_f32_32x32x32_bf16 v[80:95], v[24:27], v[64:71], v45
    ds_read_b128 v[20:23], v1 offset:27648
    s_mov_b64 exec, s[58:59]
    ds_read_b128 v[24:27], v4 offset:26624
    ds_read_b128 v[28:31], v4 offset:27136
    s_mov_b64 exec, -1
    v_exp_f32 v74, v74
    v_exp_f32 v75, v75
    v_exp_f32 v76, v76
    v_exp_f32 v77, v77
    v_exp_f32 v78, v78
    v_exp_f32 v79, v79
    v_exp_f32 v48, v48
    v_exp_f32 v49, v49
    v_smfmac_f32_32x32x32_bf16 v[80:95], v[32:35], v[72:79], v45
    v_exp_f32 v50, v50
    v_exp_f32 v51, v51
    v_exp_f32 v52, v52
    v_exp_f32 v53, v53
    s_waitcnt lgkmcnt(0)
    v_mfma_f32_32x32x16_bf16 v[64:79], v[20:23], v[36:39], 0
    v_exp_f32 v54, v54
    v_exp_f32 v55, v55
    v_exp_f32 v56, v56
    v_exp_f32 v57, v57
    v_smfmac_f32_32x32x32_bf16 v[80:95], v[24:27], v[48:55], v45
    ds_read_b128 v[16:19], v1 offset:28672
    s_mov_b64 exec, s[58:59]
    ds_read_b128 v[24:27], v4 offset:27648
    ds_read_b128 v[32:35], v4 offset:28160
    s_mov_b64 exec, -1
    v_exp_f32 v58, v58
    v_exp_f32 v59, v59
    v_exp_f32 v60, v60
    v_exp_f32 v61, v61
    v_exp_f32 v62, v62
    v_exp_f32 v63, v63
    v_exp_f32 v64, v64
    v_exp_f32 v65, v65
    v_smfmac_f32_32x32x32_bf16 v[80:95], v[28:31], v[56:63], v45
    v_exp_f32 v66, v66
    v_exp_f32 v67, v67
    v_exp_f32 v68, v68
    v_exp_f32 v69, v69
    s_waitcnt lgkmcnt(0)
    v_mfma_f32_32x32x16_bf16 v[48:63], v[16:19], v[36:39], 0
    s_waitcnt vmcnt(0)
    s_mov_b32 s32, 65536
L_chk2:
    v_cmp_ne_u64 vcc, s[56:57], v[224:225]
    s_nop 0
    s_and_b64 vcc, vcc, exec
    s_cbranch_scc0 L_ok2
    s_sub_u32 s32, s32, 1
    s_cbranch_scc1 L_ok2
    buffer_load_dwordx2 v[224:225], v10, s[24:27], s68 offen offset:256 sc1
    s_waitcnt vmcnt(0)
    s_branch L_chk2
L_ok2:
    buffer_load_dwordx4 v[40:43], v1, s[24:27], s79 offen sc1
    v_and_b32 v8, 31, v0
    v_lshlrev_b32 v8, 2, v8
    buffer_load_dword v44, v8, s[24:27], s49 offen sc1
    s_add_u32 s3, s42, 0x0
    buffer_load_dwordx4 v[96:99], v1, s[24:27], s3 offen sc1
    buffer_load_dwordx4 v[100:103], v1, s[24:27], s3 offen offset:2048 sc1
    v_exp_f32 v70, v70
    v_exp_f32 v71, v71
    v_exp_f32 v72, v72
    v_exp_f32 v73, v73
    v_smfmac_f32_32x32x32_bf16 v[80:95], v[24:27], v[64:71], v45
    ds_read_b128 v[20:23], v1 offset:29696
    s_mov_b64 exec, s[58:59]
    ds_read_b128 v[24:27], v4 offset:28672
    ds_read_b128 v[28:31], v4 offset:29184
    s_mov_b64 exec, -1
    v_exp_f32 v74, v74
    v_exp_f32 v75, v75
    v_exp_f32 v76, v76
    v_exp_f32 v77, v77
    v_exp_f32 v78, v78
    v_exp_f32 v79, v79
    v_exp_f32 v48, v48
    v_exp_f32 v49, v49
    v_smfmac_f32_32x32x32_bf16 v[80:95], v[32:35], v[72:79], v45
    v_exp_f32 v50, v50
    v_exp_f32 v51, v51
    v_exp_f32 v52, v52
    v_exp_f32 v53, v53
    s_waitcnt lgkmcnt(0)
    v_mfma_f32_32x32x16_bf16 v[64:79], v[20:23], v[36:39], 0
    s_add_u32 s3, s42, 0x1000
    buffer_load_dwordx4 v[104:107], v1, s[24:27], s3 offen sc1
    buffer_load_dwordx4 v[108:111], v1, s[24:27], s3 offen offset:2048 sc1
    v_exp_f32 v54, v54
    v_exp_f32 v55, v55
    v_exp_f32 v56, v56
    v_exp_f32 v57, v57
    v_smfmac_f32_32x32x32_bf16 v[80:95], v[24:27], v[48:55], v45
    ds_read_b128 v[16:19], v1 offset:30720
    s_mov_b64 exec, s[58:59]
    ds_read_b128 v[24:27], v4 offset:29696
    ds_read_b128 v[32:35], v4 offset:30208
    s_mov_b64 exec, -1
    v_exp_f32 v58, v58
    v_exp_f32 v59, v59
    v_exp_f32 v60, v60
    v_exp_f32 v61, v61
    v_exp_f32 v62, v62
    v_exp_f32 v63, v63
    v_exp_f32 v64, v64
    v_exp_f32 v65, v65
    v_smfmac_f32_32x32x32_bf16 v[80:95], v[28:31], v[56:63], v45
    v_exp_f32 v66, v66
    v_exp_f32 v67, v67
    v_exp_f32 v68, v68
    v_exp_f32 v69, v69
    s_waitcnt lgkmcnt(0)
    v_mfma_f32_32x32x16_bf16 v[48:63], v[16:19], v[36:39], 0
    v_exp_f32 v70, v70
    v_exp_f32 v71, v71
    v_exp_f32 v72, v72
    v_exp_f32 v73, v73
    v_smfmac_f32_32x32x32_bf16 v[80:95], v[24:27], v[64:71], v45
    ds_read_b128 v[20:23], v1 offset:31744
    s_mov_b64 exec, s[58:59]
    ds_read_b128 v[24:27], v4 offset:30720
    ds_read_b128 v[28:31], v4 offset:31232
    s_mov_b64 exec, -1
    v_exp_f32 v74, v74
    v_exp_f32 v75, v75
    v_exp_f32 v76, v76
    v_exp_f32 v77, v77
    v_exp_f32 v78, v78
    v_exp_f32 v79, v79
    v_exp_f32 v48, v48
    v_exp_f32 v49, v49
    v_smfmac_f32_32x32x32_bf16 v[80:95], v[32:35], v[72:79], v45
    s_setprio 2
    v_exp_f32 v50, v50
    v_exp_f32 v51, v51
    v_exp_f32 v52, v52
    v_exp_f32 v53, v53
    s_waitcnt lgkmcnt(0)
    v_mfma_f32_32x32x16_bf16 v[64:79], v[20:23], v[36:39], 0
    v_exp_f32 v54, v54
    v_exp_f32 v55, v55
    v_exp_f32 v56, v56
    v_exp_f32 v57, v57
    v_smfmac_f32_32x32x32_bf16 v[80:95], v[24:27], v[48:55], v45
    ds_read_b128 v[16:19], v1 offset:32768
    s_mov_b64 exec, s[58:59]
    ds_read_b128 v[24:27], v4 offset:31744
    ds_read_b128 v[32:35], v4 offset:32256
    s_mov_b64 exec, -1
    v_exp_f32 v58, v58
    v_exp_f32 v59, v59
    v_exp_f32 v60, v60
    v_exp_f32 v61, v61
    v_exp_f32 v62, v62
    v_exp_f32 v63, v63
    v_exp_f32 v64, v64
    v_exp_f32 v65, v65
    v_smfmac_f32_32x32x32_bf16 v[80:95], v[28:31], v[56:63], v45
    v_exp_f32 v66, v66
    v_exp_f32 v67, v67
    v_exp_f32 v68, v68
    v_exp_f32 v69, v69
    s_waitcnt lgkmcnt(0)
    v_mfma_f32_32x32x16_bf16 v[48:63], v[16:19], v[36:39], 0
    v_exp_f32 v70, v70
    v_exp_f32 v71, v71
    v_exp_f32 v72, v72
    v_exp_f32 v73, v73
    v_smfmac_f32_32x32x32_bf16 v[80:95], v[24:27], v[64:71], v45
    ds_read_b128 v[20:23], v1 offset:33792
    s_mov_b64 exec, s[58:59]
    ds_read_b128 v[24:27], v4 offset:32768
    ds_read_b128 v[28:31], v4 offset:33280
    s_mov_b64 exec, -1
    v_exp_f32 v74, v74
    v_exp_f32 v75, v75
    v_exp_f32 v76, v76
    v_exp_f32 v77, v77
    v_exp_f32 v78, v78
    v_exp_f32 v79, v79
    v_exp_f32 v48, v48
    v_exp_f32 v49, v49
    v_smfmac_f32_32x32x32_bf16 v[80:95], v[32:35], v[72:79], v45
    v_exp_f32 v50, v50
    v_exp_f32 v51, v51
    v_exp_f32 v52, v52
    v_exp_f32 v53, v53
    s_waitcnt lgkmcnt(0)
    v_mfma_f32_32x32x16_bf16 v[64:79], v[20:23], v[36:39], 0
    v_exp_f32 v54, v54
    v_exp_f32 v55, v55
    v_exp_f32 v56, v56
    v_exp_f32 v57, v57
    v_smfmac_f32_32x32x32_bf16 v[80:95], v[24:27], v[48:55], v45
    s_waitcnt vmcnt(0)
    v_pk_add_f32 v[96:97], v[96:97], v[104:105]
    v_pk_add_f32 v[98:99], v[98:99], v[106:107]
    v_pk_add_f32 v[100:101], v[100:101], v[108:109]
    v_pk_add_f32 v[102:103], v[102:103], v[110:111]
    v_pk_add_f32 v[96:97], v[96:97], v[100:101]
    v_pk_add_f32 v[98:99], v[98:99], v[102:103]
    s_lshl_b32 s28, s72, 11
    s_lshl_b32 s29, s71, 10
    s_add_u32 s28, s28, s29
    s_add_u32 s28, s28, 131072
    v_add_u32 v8, s28, v1
    ds_write_b128 v8, v[96:99]
    v_add_u32 v9, 131072, v1
    ds_read_b128 v[16:19], v1 offset:34816
    s_mov_b64 exec, s[58:59]
    ds_read_b128 v[24:27], v4 offset:33792
    ds_read_b128 v[32:35], v4 offset:34304
    s_mov_b64 exec, -1
    v_exp_f32 v58, v58
    v_exp_f32 v59, v59
    v_exp_f32 v60, v60
    v_exp_f32 v61, v61
    v_exp_f32 v62, v62
    v_exp_f32 v63, v63
    v_exp_f32 v64, v64
    v_exp_f32 v65, v65
    v_smfmac_f32_32x32x32_bf16 v[80:95], v[28:31], v[56:63], v45
    s_setprio 1
    v_exp_f32 v66, v66
    v_exp_f32 v67, v67
    v_exp_f32 v68, v68
    v_exp_f32 v69, v69
    s_waitcnt lgkmcnt(0)
    v_mfma_f32_32x32x16_bf16 v[48:63], v[16:19], v[36:39], 0
    v_exp_f32 v70, v70
    v_exp_f32 v71, v71
    v_exp_f32 v72, v72
    v_exp_f32 v73, v73
    v_smfmac_f32_32x32x32_bf16 v[80:95], v[24:27], v[64:71], v45
    ds_read_b128 v[20:23], v1 offset:35840
    s_mov_b64 exec, s[58:59]
    ds_read_b128 v[24:27], v4 offset:34816
    ds_read_b128 v[28:31], v4 offset:35328
    s_mov_b64 exec, -1
    v_exp_f32 v74, v74
    v_exp_f32 v75, v75
    v_exp_f32 v76, v76
    v_exp_f32 v77, v77
    v_exp_f32 v78, v78
    v_exp_f32 v79, v79
    v_exp_f32 v48, v48
    v_exp_f32 v49, v49
    v_smfmac_f32_32x32x32_bf16 v[80:95], v[32:35], v[72:79], v45
    s_setprio 0
    v_exp_f32 v50, v50
    v_exp_f32 v51, v51
    v_exp_f32 v52, v52
    v_exp_f32 v53, v53
    s_waitcnt lgkmcnt(0)
    v_mfma_f32_32x32x16_bf16 v[64:79], v[20:23], v[36:39], 0
    v_exp_f32 v54, v54
    v_exp_f32 v55, v55
    v_exp_f32 v56, v56
    v_exp_f32 v57, v57
    v_smfmac_f32_32x32x32_bf16 v[80:95], v[24:27], v[48:55], v45
    s_barrier
    ds_read_b128 v[96:99], v9 offset:0
    ds_read_b128 v[100:103], v9 offset:1024
    ds_read_b128 v[104:107], v9 offset:2048
    ds_read_b128 v[108:111], v9 offset:3072
    ds_read_b128 v[112:115], v9 offset:4096
    ds_read_b128 v[116:119], v9 offset:5120
    ds_read_b128 v[120:123], v9 offset:6144
    ds_read_b128 v[124:127], v9 offset:7168
    ds_read_b128 v[16:19], v1 offset:36864
    s_mov_b64 exec, s[58:59]
    ds_read_b128 v[24:27], v4 offset:35840
    ds_read_b128 v[32:35], v4 offset:36352
    s_mov_b64 exec, -1
    v_exp_f32 v58, v58
    v_exp_f32 v59, v59
    v_exp_f32 v60, v60
    v_exp_f32 v61, v61
    v_exp_f32 v62, v62
    v_exp_f32 v63, v63
    v_exp_f32 v64, v64
    v_exp_f32 v65, v65
    v_smfmac_f32_32x32x32_bf16 v[80:95], v[28:31], v[56:63], v45
    s_setprio 3
    v_exp_f32 v66, v66
    v_exp_f32 v67, v67
    v_exp_f32 v68, v68
    v_exp_f32 v69, v69
    s_waitcnt lgkmcnt(0)
    v_mfma_f32_32x32x16_bf16 v[48:63], v[16:19], v[36:39], 0
    v_pk_add_f32 v[96:97], v[96:97], v[112:113]
    v_pk_add_f32 v[98:99], v[98:99], v[114:115]
    v_pk_add_f32 v[100:101], v[100:101], v[116:117]
    v_pk_add_f32 v[102:103], v[102:103], v[118:119]
    v_pk_add_f32 v[104:105], v[104:105], v[120:121]
    v_pk_add_f32 v[106:107], v[106:107], v[122:123]
    v_pk_add_f32 v[108:109], v[108:109], v[124:125]
    v_pk_add_f32 v[110:111], v[110:111], v[126:127]
    v_pk_add_f32 v[96:97], v[96:97], v[104:105]
    v_pk_add_f32 v[98:99], v[98:99], v[106:107]
    v_pk_add_f32 v[100:101], v[100:101], v[108:109]
    v_pk_add_f32 v[102:103], v[102:103], v[110:111]
    v_cvt_pk_bf16_f32 v136, v96, v97
    v_cvt_pk_bf16_f32 v137, v98, v99
    v_cvt_pk_bf16_f32 v138, v100, v101
    v_cvt_pk_bf16_f32 v139, v102, v103
    v_exp_f32 v70, v70
    v_exp_f32 v71, v71
    v_exp_f32 v72, v72
    v_exp_f32 v73, v73
    v_smfmac_f32_32x32x32_bf16 v[80:95], v[24:27], v[64:71], v45
    ds_read_b128 v[20:23], v1 offset:37888
    s_mov_b64 exec, s[58:59]
    ds_read_b128 v[24:27], v4 offset:36864
    ds_read_b128 v[28:31], v4 offset:37376
    s_mov_b64 exec, -1
    v_exp_f32 v74, v74
    v_exp_f32 v75, v75
    v_exp_f32 v76, v76
    v_mfma_f32_32x32x16_bf16 v[144:159], v[136:139], v[40:43], 0
    v_exp_f32 v77, v77
    v_exp_f32 v78, v78
    v_exp_f32 v79, v79
    v_exp_f32 v48, v48
    v_exp_f32 v49, v49
    v_smfmac_f32_32x32x32_bf16 v[80:95], v[32:35], v[72:79], v45
    v_exp_f32 v50, v50
    v_exp_f32 v51, v51
    v_exp_f32 v52, v52
    v_exp_f32 v53, v53
    s_waitcnt lgkmcnt(0)
    v_mfma_f32_32x32x16_bf16 v[64:79], v[20:23], v[36:39], 0
    v_exp_f32 v54, v54
    v_exp_f32 v55, v55
    v_exp_f32 v56, v56
    v_exp_f32 v57, v57
    v_smfmac_f32_32x32x32_bf16 v[80:95], v[24:27], v[48:55], v45
    ds_read_b128 v[16:19], v1 offset:38912
    s_mov_b64 exec, s[58:59]
    ds_read_b128 v[24:27], v4 offset:37888
    ds_read_b128 v[32:35], v4 offset:38400
    s_mov_b64 exec, -1
    v_exp_f32 v58, v58
    v_exp_f32 v59, v59
    v_exp_f32 v60, v60
    v_exp_f32 v61, v61
    v_exp_f32 v62, v62
    v_exp_f32 v63, v63
    v_add_f32 v128, 0x358637bd, v152
    v_rcp_f32 v128, v128
    v_sub_f32 v129, 1.0, v44
    v_mul_f32 v128, v128, v129
    v_pk_mul_f32 v[144:145], v[144:145], v[128:129] op_sel_hi:[1,0]
    v_pk_mul_f32 v[146:147], v[146:147], v[128:129] op_sel_hi:[1,0]
    v_pk_mul_f32 v[148:149], v[148:149], v[128:129] op_sel_hi:[1,0]
    v_pk_mul_f32 v[150:151], v[150:151], v[128:129] op_sel_hi:[1,0]
    v_cvt_pk_bf16_f32 v132, v144, v145
    v_cvt_pk_bf16_f32 v133, v146, v147
    v_cvt_pk_bf16_f32 v134, v148, v149
    v_cvt_pk_bf16_f32 v135, v150, v151
    v_mov_b32 v140, -1
    v_mov_b32 v141, -1
    v_mov_b32 v142, -1
    v_mov_b32 v143, -1
    buffer_store_dwordx4 v[140:143], v1, s[24:27], s43 offen sc1
    s_add_u32 s3, s43, 0x8000
    buffer_store_dwordx4 v[132:135], v1, s[24:27], s3 offen sc1
    v_exp_f32 v64, v64
    v_exp_f32 v65, v65
    v_smfmac_f32_32x32x32_bf16 v[80:95], v[28:31], v[56:63], v45
    v_exp_f32 v66, v66
    v_exp_f32 v67, v67
    v_exp_f32 v68, v68
    v_exp_f32 v69, v69
    s_waitcnt lgkmcnt(0)
    v_mfma_f32_32x32x16_bf16 v[48:63], v[16:19], v[36:39], 0
    v_exp_f32 v70, v70
    v_exp_f32 v71, v71
    v_exp_f32 v72, v72
    v_exp_f32 v73, v73
    v_smfmac_f32_32x32x32_bf16 v[80:95], v[24:27], v[64:71], v45
    ds_read_b128 v[20:23], v1 offset:39936
    s_mov_b64 exec, s[58:59]
    ds_read_b128 v[24:27], v4 offset:38912
    ds_read_b128 v[28:31], v4 offset:39424
    s_mov_b64 exec, -1
    v_exp_f32 v74, v74
    v_exp_f32 v75, v75
    v_exp_f32 v76, v76
    v_exp_f32 v77, v77
    v_exp_f32 v78, v78
    v_exp_f32 v79, v79
    v_exp_f32 v48, v48
    v_exp_f32 v49, v49
    v_smfmac_f32_32x32x32_bf16 v[80:95], v[32:35], v[72:79], v45
    v_exp_f32 v50, v50
    v_exp_f32 v51, v51
    v_exp_f32 v52, v52
    v_exp_f32 v53, v53
    s_waitcnt lgkmcnt(0)
    v_mfma_f32_32x32x16_bf16 v[64:79], v[20:23], v[36:39], 0
    s_add_u32 m0, s48, 0
    s_add_u32 s3, s37, 0x0
    buffer_load_dwordx4 v5, s[16:19], s3 offen lds
    v_exp_f32 v54, v54
    v_exp_f32 v55, v55
    v_exp_f32 v56, v56
    v_exp_f32 v57, v57
    v_smfmac_f32_32x32x32_bf16 v[80:95], v[24:27], v[48:55], v45
    ds_read_b128 v[16:19], v1 offset:40960
    s_mov_b64 exec, s[58:59]
    ds_read_b128 v[24:27], v4 offset:39936
    ds_read_b128 v[32:35], v4 offset:40448
    s_mov_b64 exec, -1
    v_exp_f32 v58, v58
    v_exp_f32 v59, v59
    v_exp_f32 v60, v60
    v_exp_f32 v61, v61
    v_exp_f32 v62, v62
    v_exp_f32 v63, v63
    v_exp_f32 v64, v64
    v_exp_f32 v65, v65
    v_smfmac_f32_32x32x32_bf16 v[80:95], v[28:31], v[56:63], v45
    v_exp_f32 v66, v66
    v_exp_f32 v67, v67
    v_exp_f32 v68, v68
    v_exp_f32 v69, v69
    s_waitcnt lgkmcnt(0)
    v_mfma_f32_32x32x16_bf16 v[48:63], v[16:19], v[36:39], 0
    s_add_u32 m0, s48, 1024
    s_add_u32 s3, s37, 0x2000
    buffer_load_dwordx4 v5, s[16:19], s3 offen lds
    v_exp_f32 v70, v70
    v_exp_f32 v71, v71
    v_exp_f32 v72, v72
    v_exp_f32 v73, v73
    v_smfmac_f32_32x32x32_bf16 v[80:95], v[24:27], v[64:71], v45
    ds_read_b128 v[20:23], v1 offset:41984
    s_mov_b64 exec, s[58:59]
    ds_read_b128 v[24:27], v4 offset:40960
    ds_read_b128 v[28:31], v4 offset:41472
    s_mov_b64 exec, -1
    v_exp_f32 v74, v74
    v_exp_f32 v75, v75
    v_exp_f32 v76, v76
    v_exp_f32 v77, v77
    v_exp_f32 v78, v78
    v_exp_f32 v79, v79
    v_exp_f32 v48, v48
    v_exp_f32 v49, v49
    v_smfmac_f32_32x32x32_bf16 v[80:95], v[32:35], v[72:79], v45
    v_exp_f32 v50, v50
    v_exp_f32 v51, v51
    v_exp_f32 v52, v52
    v_exp_f32 v53, v53
    s_waitcnt lgkmcnt(0)
    v_mfma_f32_32x32x16_bf16 v[64:79], v[20:23], v[36:39], 0
    s_add_u32 m0, s48, 2048
    s_add_u32 s3, s37, 0x4000
    buffer_load_dwordx4 v5, s[16:19], s3 offen lds
    v_exp_f32 v54, v54
    v_exp_f32 v55, v55
    v_exp_f32 v56, v56
    v_exp_f32 v57, v57
    v_smfmac_f32_32x32x32_bf16 v[80:95], v[24:27], v[48:55], v45
    ds_read_b128 v[16:19], v1 offset:43008
    s_mov_b64 exec, s[58:59]
    ds_read_b128 v[24:27], v4 offset:41984
    ds_read_b128 v[32:35], v4 offset:42496
    s_mov_b64 exec, -1
    v_exp_f32 v58, v58
    v_exp_f32 v59, v59
    v_exp_f32 v60, v60
    v_exp_f32 v61, v61
    v_exp_f32 v62, v62
    v_exp_f32 v63, v63
    v_exp_f32 v64, v64
    v_exp_f32 v65, v65
    v_smfmac_f32_32x32x32_bf16 v[80:95], v[28:31], v[56:63], v45
    s_setprio 2
    v_exp_f32 v66, v66
    v_exp_f32 v67, v67
    v_exp_f32 v68, v68
    v_exp_f32 v69, v69
    s_waitcnt lgkmcnt(0)
    v_mfma_f32_32x32x16_bf16 v[48:63], v[16:19], v[36:39], 0
    s_add_u32 m0, s48, 3072
    s_add_u32 s3, s37, 0x6000
    buffer_load_dwordx4 v5, s[16:19], s3 offen lds
    v_exp_f32 v70, v70
    v_exp_f32 v71, v71
    v_exp_f32 v72, v72
    v_exp_f32 v73, v73
    v_smfmac_f32_32x32x32_bf16 v[80:95], v[24:27], v[64:71], v45
    ds_read_b128 v[20:23], v1 offset:44032
    s_mov_b64 exec, s[58:59]
    ds_read_b128 v[24:27], v4 offset:43008
    ds_read_b128 v[28:31], v4 offset:43520
    s_mov_b64 exec, -1
    v_exp_f32 v74, v74
    v_exp_f32 v75, v75
    v_exp_f32 v76, v76
    v_exp_f32 v77, v77
    v_exp_f32 v78, v78
    v_exp_f32 v79, v79
    v_exp_f32 v48, v48
    v_exp_f32 v49, v49
    v_smfmac_f32_32x32x32_bf16 v[80:95], v[32:35], v[72:79], v45
    v_exp_f32 v50, v50
    v_exp_f32 v51, v51
    v_exp_f32 v52, v52
    v_exp_f32 v53, v53
    s_waitcnt lgkmcnt(0)
    v_mfma_f32_32x32x16_bf16 v[64:79], v[20:23], v[36:39], 0
    s_add_u32 m0, s48, 4096
    s_add_u32 s3, s37, 0x8000
    buffer_load_dwordx4 v5, s[16:19], s3 offen lds
    s_waitcnt vmcnt(5)
    s_mov_b64 exec, 0xff
    buffer_store_dwordx2 v[46:47], v14, s[24:27], s77 offen offset:1024 sc1
    s_mov_b64 exec, -1
    v_exp_f32 v54, v54
    v_exp_f32 v55, v55
    v_exp_f32 v56, v56
    v_exp_f32 v57, v57
    v_smfmac_f32_32x32x32_bf16 v[80:95], v[24:27], v[48:55], v45
    ds_read_b128 v[16:19], v1 offset:45056
    s_mov_b64 exec, s[58:59]
    ds_read_b128 v[24:27], v4 offset:44032
    ds_read_b128 v[32:35], v4 offset:44544
    s_mov_b64 exec, -1
    v_exp_f32 v58, v58
    v_exp_f32 v59, v59
    v_exp_f32 v60, v60
    v_exp_f32 v61, v61
    v_exp_f32 v62, v62
    v_exp_f32 v63, v63
    v_exp_f32 v64, v64
    v_exp_f32 v65, v65
    v_smfmac_f32_32x32x32_bf16 v[80:95], v[28:31], v[56:63], v45
    v_exp_f32 v66, v66
    v_exp_f32 v67, v67
    v_exp_f32 v68, v68
    v_exp_f32 v69, v69
    s_waitcnt lgkmcnt(0)
    v_mfma_f32_32x32x16_bf16 v[48:63], v[16:19], v[36:39], 0
    s_add_u32 m0, s48, 5120
    s_add_u32 s3, s37, 0xa000
    buffer_load_dwordx4 v5, s[16:19], s3 offen lds
    v_exp_f32 v70, v70
    v_exp_f32 v71, v71
    v_exp_f32 v72, v72
    v_exp_f32 v73, v73
    v_smfmac_f32_32x32x32_bf16 v[80:95], v[24:27], v[64:71], v45
    ds_read_b128 v[20:23], v1 offset:46080
    s_mov_b64 exec, s[58:59]
    ds_read_b128 v[24:27], v4 offset:45056
    ds_read_b128 v[28:31], v4 offset:45568
    s_mov_b64 exec, -1
    v_exp_f32 v74, v74
    v_exp_f32 v75, v75
    v_exp_f32 v76, v76
    v_exp_f32 v77, v77
    v_exp_f32 v78, v78
    v_exp_f32 v79, v79
    v_exp_f32 v48, v48
    v_exp_f32 v49, v49
    v_smfmac_f32_32x32x32_bf16 v[80:95], v[32:35], v[72:79], v45
    v_exp_f32 v50, v50
    v_exp_f32 v51, v51
    v_exp_f32 v52, v52
    v_exp_f32 v53, v53
    s_waitcnt lgkmcnt(0)
    v_mfma_f32_32x32x16_bf16 v[64:79], v[20:23], v[36:39], 0
    s_add_u32 m0, s48, 6144
    s_add_u32 s3, s37, 0xc000
    buffer_load_dwordx4 v5, s[16:19], s3 offen lds
    v_exp_f32 v54, v54
    v_exp_f32 v55, v55
    v_exp_f32 v56, v56
    v_exp_f32 v57, v57
    v_smfmac_f32_32x32x32_bf16 v[80:95], v[24:27], v[48:55], v45
    ds_read_b128 v[16:19], v1 offset:47104
    s_mov_b64 exec, s[58:59]
    ds_read_b128 v[24:27], v4 offset:46080
    ds_read_b128 v[32:35], v4 offset:46592
    s_mov_b64 exec, -1
    v_exp_f32 v58, v58
    v_exp_f32 v59, v59
    v_exp_f32 v60, v60
    v_exp_f32 v61, v61
    v_exp_f32 v62, v62
    v_exp_f32 v63, v63
    v_exp_f32 v64, v64
    v_exp_f32 v65, v65
    v_smfmac_f32_32x32x32_bf16 v[80:95], v[28:31], v[56:63], v45
    v_exp_f32 v66, v66
    v_exp_f32 v67, v67
    v_exp_f32 v68, v68
    v_exp_f32 v69, v69
    s_waitcnt lgkmcnt(0)
    v_mfma_f32_32x32x16_bf16 v[48:63], v[16:19], v[36:39], 0
    s_add_u32 m0, s48, 7168
    s_add_u32 s3, s37, 0xe000
    buffer_load_dwordx4 v5, s[16:19], s3 offen lds
    v_exp_f32 v70, v70
    v_exp_f32 v71, v71
    v_exp_f32 v72, v72
    v_exp_f32 v73, v73
    v_smfmac_f32_32x32x32_bf16 v[80:95], v[24:27], v[64:71], v45
    ds_read_b128 v[20:23], v1 offset:48128
    s_mov_b64 exec, s[58:59]
    ds_read_b128 v[24:27], v4 offset:47104
    ds_read_b128 v[28:31], v4 offset:47616
    s_mov_b64 exec, -1
    v_exp_f32 v74, v74
    v_exp_f32 v75, v75
    v_exp_f32 v76, v76
    v_exp_f32 v77, v77
    v_exp_f32 v78, v78
    v_exp_f32 v79, v79
    v_exp_f32 v48, v48
    v_exp_f32 v49, v49
    v_smfmac_f32_32x32x32_bf16 v[80:95], v[32:35], v[72:79], v45
    s_setprio 1
    v_exp_f32 v50, v50
    v_exp_f32 v51, v51
    v_exp_f32 v52, v52
    v_exp_f32 v53, v53
    s_waitcnt lgkmcnt(0)
    v_mfma_f32_32x32x16_bf16 v[64:79], v[20:23], v[36:39], 0
    v_exp_f32 v54, v54
    v_exp_f32 v55, v55
    v_exp_f32 v56, v56
    v_exp_f32 v57, v57
    v_smfmac_f32_32x32x32_bf16 v[80:95], v[24:27], v[48:55], v45
    ds_read_b128 v[16:19], v1 offset:49152
    s_mov_b64 exec, s[58:59]
    ds_read_b128 v[24:27], v4 offset:48128
    ds_read_b128 v[32:35], v4 offset:48640
    s_mov_b64 exec, -1
    v_exp_f32 v58, v58
    v_exp_f32 v59, v59
    v_exp_f32 v60, v60
    v_exp_f32 v61, v61
    v_exp_f32 v62, v62
    v_exp_f32 v63, v63
    v_exp_f32 v64, v64
    v_exp_f32 v65, v65
    v_smfmac_f32_32x32x32_bf16 v[80:95], v[28:31], v[56:63], v45
    v_exp_f32 v66, v66
    v_exp_f32 v67, v67
    v_exp_f32 v68, v68
    v_exp_f32 v69, v69
    s_waitcnt lgkmcnt(0)
    v_mfma_f32_32x32x16_bf16 v[48:63], v[16:19], v[36:39], 0
    v_exp_f32 v70, v70
    v_exp_f32 v71, v71
    v_exp_f32 v72, v72
    v_exp_f32 v73, v73
    v_smfmac_f32_32x32x32_bf16 v[80:95], v[24:27], v[64:71], v45
    ds_read_b128 v[20:23], v1 offset:50176
    s_mov_b64 exec, s[58:59]
    ds_read_b128 v[24:27], v4 offset:49152
    ds_read_b128 v[28:31], v4 offset:49664
    s_mov_b64 exec, -1
    v_exp_f32 v74, v74
    v_exp_f32 v75, v75
    v_exp_f32 v76, v76
    v_exp_f32 v77, v77
    v_exp_f32 v78, v78
    v_exp_f32 v79, v79
    v_exp_f32 v48, v48
    v_exp_f32 v49, v49
    v_smfmac_f32_32x32x32_bf16 v[80:95], v[32:35], v[72:79], v45
    s_setprio 0
    v_exp_f32 v50, v50
    v_exp_f32 v51, v51
    v_exp_f32 v52, v52
    v_exp_f32 v53, v53
    s_waitcnt lgkmcnt(0)
    v_mfma_f32_32x32x16_bf16 v[64:79], v[20:23], v[36:39], 0
    v_exp_f32 v54, v54
    v_exp_f32 v55, v55
    v_exp_f32 v56, v56
    v_exp_f32 v57, v57
    v_smfmac_f32_32x32x32_bf16 v[80:95], v[24:27], v[48:55], v45
    s_waitcnt vmcnt(0)
    s_barrier
    ds_read_b64_tr_b16 v[160:161], v6 offset:0
    ds_read_b64_tr_b16 v[162:163], v6 offset:1024
    ds_read_b64_tr_b16 v[164:165], v7 offset:0
    ds_read_b64_tr_b16 v[166:167], v7 offset:1024
    ds_read_b128 v[16:19], v1 offset:51200
    s_mov_b64 exec, s[58:59]
    ds_read_b128 v[24:27], v4 offset:50176
    ds_read_b128 v[32:35], v4 offset:50688
    s_mov_b64 exec, -1
    v_exp_f32 v58, v58
    v_exp_f32 v59, v59
    v_exp_f32 v60, v60
    v_exp_f32 v61, v61
    v_exp_f32 v62, v62
    v_exp_f32 v63, v63
    v_exp_f32 v64, v64
    v_exp_f32 v65, v65
    v_smfmac_f32_32x32x32_bf16 v[80:95], v[28:31], v[56:63], v45
    s_setprio 3
    v_exp_f32 v66, v66
    v_exp_f32 v67, v67
    v_exp_f32 v68, v68
    v_exp_f32 v69, v69
    s_waitcnt lgkmcnt(0)
    v_mfma_f32_32x32x16_bf16 v[48:63], v[16:19], v[36:39], 0
    s_add_u32 s48, s48, s53
    s_add_u32 m0, s48, 0
    s_add_u32 s3, s37, 0x0
    buffer_load_dwordx4 v5, s[12:15], s3 offen lds
    v_exp_f32 v70, v70
    v_exp_f32 v71, v71
    v_exp_f32 v72, v72
    v_exp_f32 v73, v73
    v_smfmac_f32_32x32x32_bf16 v[80:95], v[24:27], v[64:71], v45
    ds_read_b64_tr_b16 v[168:169], v6 offset:2048
    ds_read_b64_tr_b16 v[170:171], v6 offset:3072
    ds_read_b64_tr_b16 v[172:173], v7 offset:2048
    ds_read_b64_tr_b16 v[174:175], v7 offset:3072
    ds_read_b128 v[20:23], v1 offset:52224
    s_mov_b64 exec, s[58:59]
    ds_read_b128 v[24:27], v4 offset:51200
    ds_read_b128 v[28:31], v4 offset:51712
    s_mov_b64 exec, -1
    v_exp_f32 v74, v74
    v_exp_f32 v75, v75
    v_exp_f32 v76, v76
    v_exp_f32 v77, v77
    v_exp_f32 v78, v78
    v_exp_f32 v79, v79
    v_exp_f32 v48, v48
    v_exp_f32 v49, v49
    v_smfmac_f32_32x32x32_bf16 v[80:95], v[32:35], v[72:79], v45
    v_exp_f32 v50, v50
    v_exp_f32 v51, v51
    v_exp_f32 v52, v52
    v_exp_f32 v53, v53
    s_waitcnt lgkmcnt(0)
    v_mfma_f32_32x32x16_bf16 v[64:79], v[20:23], v[36:39], 0
    s_add_u32 m0, s48, 1024
    s_add_u32 s3, s37, 0x2000
    buffer_load_dwordx4 v5, s[12:15], s3 offen lds
    v_exp_f32 v54, v54
    v_exp_f32 v55, v55
    v_exp_f32 v56, v56
    v_exp_f32 v57, v57
    v_smfmac_f32_32x32x32_bf16 v[80:95], v[24:27], v[48:55], v45
    ds_read_b64_tr_b16 v[176:177], v6 offset:4096
    ds_read_b64_tr_b16 v[178:179], v6 offset:5120
    ds_read_b64_tr_b16 v[180:181], v7 offset:4096
    ds_read_b64_tr_b16 v[182:183], v7 offset:5120
    ds_read_b128 v[16:19], v1 offset:53248
    s_mov_b64 exec, s[58:59]
    ds_read_b128 v[24:27], v4 offset:52224
    ds_read_b128 v[32:35], v4 offset:52736
    s_mov_b64 exec, -1
    v_exp_f32 v58, v58
    v_exp_f32 v59, v59
    v_exp_f32 v60, v60
    v_exp_f32 v61, v61
    v_exp_f32 v62, v62
    v_exp_f32 v63, v63
    v_exp_f32 v64, v64
    v_exp_f32 v65, v65
    v_smfmac_f32_32x32x32_bf16 v[80:95], v[28:31], v[56:63], v45
    v_exp_f32 v66, v66
    v_exp_f32 v67, v67
    v_exp_f32 v68, v68
    v_exp_f32 v69, v69
    s_waitcnt lgkmcnt(0)
    v_mfma_f32_32x32x16_bf16 v[48:63], v[16:19], v[36:39], 0
    s_mov_b64 exec, 0xff
    buffer_load_dwordx2 v[224:225], v10, s[24:27], s75 offen offset:1024 sc1
    s_mov_b64 exec, -1
    s_add_u32 m0, s48, 2048
    s_add_u32 s3, s37, 0x4000
    buffer_load_dwordx4 v5, s[12:15], s3 offen lds
    v_exp_f32 v70, v70
    v_exp_f32 v71, v71
    v_exp_f32 v72, v72
    v_exp_f32 v73, v73
    v_smfmac_f32_32x32x32_bf16 v[80:95], v[24:27], v[64:71], v45
    ds_read_b64_tr_b16 v[184:185], v6 offset:6144
    ds_read_b64_tr_b16 v[186:187], v6 offset:7168
    ds_read_b64_tr_b16 v[188:189], v7 offset:6144
    ds_read_b64_tr_b16 v[190:191], v7 offset:7168
    ds_read_b128 v[20:23], v1 offset:54272
    s_mov_b64 exec, s[58:59]
    ds_read_b128 v[24:27], v4 offset:53248
    ds_read_b128 v[28:31], v4 offset:53760
    s_mov_b64 exec, -1
    v_exp_f32 v74, v74
    v_exp_f32 v75, v75
    v_exp_f32 v76, v76
    v_exp_f32 v77, v77
    v_exp_f32 v78, v78
    v_exp_f32 v79, v79
    v_exp_f32 v48, v48
    v_exp_f32 v49, v49
    v_smfmac_f32_32x32x32_bf16 v[80:95], v[32:35], v[72:79], v45
    v_exp_f32 v50, v50
    v_exp_f32 v51, v51
    v_exp_f32 v52, v52
    v_exp_f32 v53, v53
    s_waitcnt lgkmcnt(0)
    v_mfma_f32_32x32x16_bf16 v[64:79], v[20:23], v[36:39], 0
    s_add_u32 m0, s48, 3072
    s_add_u32 s3, s37, 0x6000
    buffer_load_dwordx4 v5, s[12:15], s3 offen lds
    v_exp_f32 v54, v54
    v_exp_f32 v55, v55
    v_exp_f32 v56, v56
    v_exp_f32 v57, v57
    v_smfmac_f32_32x32x32_bf16 v[80:95], v[24:27], v[48:55], v45
    ds_read_b64_tr_b16 v[192:193], v6 offset:8192
    ds_read_b64_tr_b16 v[194:195], v6 offset:9216
    ds_read_b64_tr_b16 v[196:197], v7 offset:8192
    ds_read_b64_tr_b16 v[198:199], v7 offset:9216
    ds_read_b128 v[16:19], v1 offset:55296
    s_mov_b64 exec, s[58:59]
    ds_read_b128 v[24:27], v4 offset:54272
    ds_read_b128 v[32:35], v4 offset:54784
    s_mov_b64 exec, -1
    v_exp_f32 v58, v58
    v_exp_f32 v59, v59
    v_exp_f32 v60, v60
    v_exp_f32 v61, v61
    v_exp_f32 v62, v62
    v_exp_f32 v63, v63
    v_exp_f32 v64, v64
    v_exp_f32 v65, v65
    v_smfmac_f32_32x32x32_bf16 v[80:95], v[28:31], v[56:63], v45
    v_exp_f32 v66, v66
    v_exp_f32 v67, v67
    v_exp_f32 v68, v68
    v_exp_f32 v69, v69
    s_waitcnt lgkmcnt(0)
    v_mfma_f32_32x32x16_bf16 v[48:63], v[16:19], v[36:39], 0
    s_add_u32 m0, s48, 4096
    s_add_u32 s3, s37, 0x8000
    buffer_load_dwordx4 v5, s[12:15], s3 offen lds
    v_exp_f32 v70, v70
    v_exp_f32 v71, v71
    v_exp_f32 v72, v72
    v_exp_f32 v73, v73
    v_smfmac_f32_32x32x32_bf16 v[80:95], v[24:27], v[64:71], v45
    ds_read_b64_tr_b16 v[200:201], v6 offset:10240
    ds_read_b64_tr_b16 v[202:203], v6 offset:11264
    ds_read_b64_tr_b16 v[204:205], v7 offset:10240
    ds_read_b64_tr_b16 v[206:207], v7 offset:11264
    ds_read_b128 v[20:23], v1 offset:56320
    s_mov_b64 exec, s[58:59]
    ds_read_b128 v[24:27], v4 offset:55296
    ds_read_b128 v[28:31], v4 offset:55808
    s_mov_b64 exec, -1
    v_exp_f32 v74, v74
    v_exp_f32 v75, v75
    v_exp_f32 v76, v76
    v_exp_f32 v77, v77
    v_exp_f32 v78, v78
    v_exp_f32 v79, v79
    v_exp_f32 v48, v48
    v_exp_f32 v49, v49
    v_smfmac_f32_32x32x32_bf16 v[80:95], v[32:35], v[72:79], v45
    v_exp_f32 v50, v50
    v_exp_f32 v51, v51
    v_exp_f32 v52, v52
    v_exp_f32 v53, v53
    s_waitcnt lgkmcnt(0)
    v_mfma_f32_32x32x16_bf16 v[64:79], v[20:23], v[36:39], 0
    s_add_u32 m0, s48, 5120
    s_add_u32 s3, s37, 0xa000
    buffer_load_dwordx4 v5, s[12:15], s3 offen lds
    v_exp_f32 v54, v54
    v_exp_f32 v55, v55
    v_exp_f32 v56, v56
    v_exp_f32 v57, v57
    v_smfmac_f32_32x32x32_bf16 v[80:95], v[24:27], v[48:55], v45
    ds_read_b64_tr_b16 v[208:209], v6 offset:12288
    ds_read_b64_tr_b16 v[210:211], v6 offset:13312
    ds_read_b64_tr_b16 v[212:213], v7 offset:12288
    ds_read_b64_tr_b16 v[214:215], v7 offset:13312
    ds_read_b128 v[16:19], v1 offset:57344
    s_mov_b64 exec, s[58:59]
    ds_read_b128 v[24:27], v4 offset:56320
    ds_read_b128 v[32:35], v4 offset:56832
    s_mov_b64 exec, -1
    v_exp_f32 v58, v58
    v_exp_f32 v59, v59
    v_exp_f32 v60, v60
    v_exp_f32 v61, v61
    v_exp_f32 v62, v62
    v_exp_f32 v63, v63
    v_exp_f32 v64, v64
    v_exp_f32 v65, v65
    v_smfmac_f32_32x32x32_bf16 v[80:95], v[28:31], v[56:63], v45
    v_exp_f32 v66, v66
    v_exp_f32 v67, v67
    v_exp_f32 v68, v68
    v_exp_f32 v69, v69
    s_waitcnt lgkmcnt(0)
    v_mfma_f32_32x32x16_bf16 v[48:63], v[16:19], v[36:39], 0
    s_add_u32 m0, s48, 6144
    s_add_u32 s3, s37, 0xc000
    buffer_load_dwordx4 v5, s[12:15], s3 offen lds
    v_exp_f32 v70, v70
    v_exp_f32 v71, v71
    v_exp_f32 v72, v72
    v_exp_f32 v73, v73
    v_smfmac_f32_32x32x32_bf16 v[80:95], v[24:27], v[64:71], v45
    ds_read_b64_tr_b16 v[216:217], v6 offset:14336
    ds_read_b64_tr_b16 v[218:219], v6 offset:15360
    ds_read_b64_tr_b16 v[220:221], v7 offset:14336
    ds_read_b64_tr_b16 v[222:223], v7 offset:15360
    ds_read_b128 v[20:23], v1 offset:58368
    s_mov_b64 exec, s[58:59]
    ds_read_b128 v[24:27], v4 offset:57344
    ds_read_b128 v[28:31], v4 offset:57856
    s_mov_b64 exec, -1
    v_exp_f32 v74, v74
    v_exp_f32 v75, v75
    v_exp_f32 v76, v76
    v_exp_f32 v77, v77
    v_exp_f32 v78, v78
    v_exp_f32 v79, v79
    v_exp_f32 v48, v48
    v_exp_f32 v49, v49
    v_smfmac_f32_32x32x32_bf16 v[80:95], v[32:35], v[72:79], v45
    v_exp_f32 v50, v50
    v_exp_f32 v51, v51
    v_exp_f32 v52, v52
    v_exp_f32 v53, v53
    s_waitcnt lgkmcnt(0)
    v_mfma_f32_32x32x16_bf16 v[64:79], v[20:23], v[36:39], 0
    s_add_u32 m0, s48, 7168
    s_add_u32 s3, s37, 0xe000
    buffer_load_dwordx4 v5, s[12:15], s3 offen lds
    s_waitcnt vmcnt(6)
    s_mov_b32 s32, 65536
L_chk3:
    v_cmp_ne_u64 vcc, s[56:57], v[224:225]
    s_nop 0
    s_and_b64 vcc, vcc, 0xff
    s_cbranch_scc0 L_ok3
    s_sub_u32 s32, s32, 1
    s_cbranch_scc1 L_ok3
    s_mov_b64 exec, 0xff
    buffer_load_dwordx2 v[224:225], v10, s[24:27], s75 offen offset:1024 sc1
    s_mov_b64 exec, -1
    s_waitcnt vmcnt(0)
    s_branch L_chk3
L_ok3:
    s_add_u32 s3, s36, 0x8000
    buffer_load_dwordx4 v[96:99], v1, s[24:27], s3 offen offset:0 sc1
    buffer_load_dwordx4 v[100:103], v1, s[24:27], s3 offen offset:1024 sc1
    v_exp_f32 v54, v54
    v_exp_f32 v55, v55
    v_exp_f32 v56, v56
    v_exp_f32 v57, v57
    v_smfmac_f32_32x32x32_bf16 v[80:95], v[24:27], v[48:55], v45
    ds_read_b128 v[16:19], v1 offset:59392
    s_mov_b64 exec, s[58:59]
    ds_read_b128 v[24:27], v4 offset:58368
    ds_read_b128 v[32:35], v4 offset:58880
    s_mov_b64 exec, -1
    v_exp_f32 v58, v58
    v_exp_f32 v59, v59
    v_exp_f32 v60, v60
    v_exp_f32 v61, v61
    v_exp_f32 v62, v62
    v_exp_f32 v63, v63
    v_exp_f32 v64, v64
    v_exp_f32 v65, v65
    v_smfmac_f32_32x32x32_bf16 v[80:95], v[28:31], v[56:63], v45
    v_exp_f32 v66, v66
    v_exp_f32 v67, v67
    v_exp_f32 v68, v68
    v_exp_f32 v69, v69
    s_waitcnt lgkmcnt(0)
    v_mfma_f32_32x32x16_bf16 v[48:63], v[16:19], v[36:39], 0
    s_add_u32 s3, s36, 0x8000
    buffer_load_dwordx4 v[104:107], v1, s[24:27], s3 offen offset:2048 sc1
    buffer_load_dwordx4 v[108:111], v1, s[24:27], s3 offen offset:3072 sc1
    v_exp_f32 v70, v70
    v_exp_f32 v71, v71
    v_exp_f32 v72, v72
    v_exp_f32 v73, v73
    v_smfmac_f32_32x32x32_bf16 v[80:95], v[24:27], v[64:71], v45
    ds_read_b128 v[20:23], v1 offset:60416
    s_mov_b64 exec, s[58:59]
    ds_read_b128 v[24:27], v4 offset:59392
    ds_read_b128 v[28:31], v4 offset:59904
    s_mov_b64 exec, -1
    v_exp_f32 v74, v74
    v_exp_f32 v75, v75
    v_exp_f32 v76, v76
    v_exp_f32 v77, v77
    v_exp_f32 v78, v78
    v_exp_f32 v79, v79
    v_exp_f32 v48, v48
    v_exp_f32 v49, v49
    v_smfmac_f32_32x32x32_bf16 v[80:95], v[32:35], v[72:79], v45
    v_exp_f32 v50, v50
    v_exp_f32 v51, v51
    v_exp_f32 v52, v52
    v_exp_f32 v53, v53
    s_waitcnt lgkmcnt(0)
    v_mfma_f32_32x32x16_bf16 v[64:79], v[20:23], v[36:39], 0
    s_add_u32 s3, s36, 0x9000
    buffer_load_dwordx4 v[112:115], v1, s[24:27], s3 offen offset:0 sc1
    buffer_load_dwordx4 v[116:119], v1, s[24:27], s3 offen offset:1024 sc1
    v_exp_f32 v54, v54
    v_exp_f32 v55, v55
    v_exp_f32 v56, v56
    v_exp_f32 v57, v57
    v_smfmac_f32_32x32x32_bf16 v[80:95], v[24:27], v[48:55], v45
    ds_read_b128 v[16:19], v1 offset:61440
    s_mov_b64 exec, s[58:59]
    ds_read_b128 v[24:27], v4 offset:60416
    ds_read_b128 v[32:35], v4 offset:60928
    s_mov_b64 exec, -1
    v_exp_f32 v58, v58
    v_exp_f32 v59, v59
    v_exp_f32 v60, v60
    v_exp_f32 v61, v61
    v_exp_f32 v62, v62
    v_exp_f32 v63, v63
    v_exp_f32 v64, v64
    v_exp_f32 v65, v65
    v_smfmac_f32_32x32x32_bf16 v[80:95], v[28:31], v[56:63], v45
    v_exp_f32 v66, v66
    v_exp_f32 v67, v67
    v_exp_f32 v68, v68
    v_exp_f32 v69, v69
    s_waitcnt lgkmcnt(0)
    v_mfma_f32_32x32x16_bf16 v[48:63], v[16:19], v[36:39], 0
    s_add_u32 s3, s36, 0x9000
    buffer_load_dwordx4 v[120:123], v1, s[24:27], s3 offen offset:2048 sc1
    buffer_load_dwordx4 v[124:127], v1, s[24:27], s3 offen offset:3072 sc1
    v_exp_f32 v70, v70
    v_exp_f32 v71, v71
    v_exp_f32 v72, v72
    v_exp_f32 v73, v73
    v_smfmac_f32_32x32x32_bf16 v[80:95], v[24:27], v[64:71], v45
    ds_read_b128 v[20:23], v1 offset:62464
    s_mov_b64 exec, s[58:59]
    ds_read_b128 v[24:27], v4 offset:61440
    ds_read_b128 v[28:31], v4 offset:61952
    s_mov_b64 exec, -1
    v_exp_f32 v74, v74
    v_exp_f32 v75, v75
    v_exp_f32 v76, v76
    v_exp_f32 v77, v77
    v_exp_f32 v78, v78
    v_exp_f32 v79, v79
    v_exp_f32 v48, v48
    v_exp_f32 v49, v49
    v_smfmac_f32_32x32x32_bf16 v[80:95], v[32:35], v[72:79], v45
    s_setprio 2
    v_exp_f32 v50, v50
    v_exp_f32 v51, v51
    v_exp_f32 v52, v52
    v_exp_f32 v53, v53
    s_waitcnt lgkmcnt(0)
    v_mfma_f32_32x32x16_bf16 v[64:79], v[20:23], v[36:39], 0
    v_exp_f32 v54, v54
    v_exp_f32 v55, v55
    v_exp_f32 v56, v56
    v_exp_f32 v57, v57
    v_smfmac_f32_32x32x32_bf16 v[80:95], v[24:27], v[48:55], v45
    ds_read_b128 v[16:19], v1 offset:63488
    s_mov_b64 exec, s[58:59]
    ds_read_b128 v[24:27], v4 offset:62464
    ds_read_b128 v[32:35], v4 offset:62976
    s_mov_b64 exec, -1
    v_exp_f32 v58, v58
    v_exp_f32 v59, v59
    v_exp_f32 v60, v60
    v_exp_f32 v61, v61
    v_exp_f32 v62, v62
    v_exp_f32 v63, v63
    v_exp_f32 v64, v64
    v_exp_f32 v65, v65
    v_smfmac_f32_32x32x32_bf16 v[80:95], v[28:31], v[56:63], v45
    v_exp_f32 v66, v66
    v_exp_f32 v67, v67
    v_exp_f32 v68, v68
    v_exp_f32 v69, v69
    s_waitcnt lgkmcnt(0)
    v_mfma_f32_32x32x16_bf16 v[48:63], v[16:19], v[36:39], 0
    v_exp_f32 v70, v70
    v_exp_f32 v71, v71
    v_exp_f32 v72, v72
    v_exp_f32 v73, v73
    v_smfmac_f32_32x32x32_bf16 v[80:95], v[24:27], v[64:71], v45
    ds_read_b128 v[20:23], v1 offset:64512
    s_mov_b64 exec, s[58:59]
    ds_read_b128 v[24:27], v4 offset:63488
    ds_read_b128 v[28:31], v4 offset:64000
    s_mov_b64 exec, -1
    v_exp_f32 v74, v74
    v_exp_f32 v75, v75
    v_exp_f32 v76, v76
    v_exp_f32 v77, v77
    v_exp_f32 v78, v78
    v_exp_f32 v79, v79
    v_exp_f32 v48, v48
    v_exp_f32 v49, v49
    v_smfmac_f32_32x32x32_bf16 v[80:95], v[32:35], v[72:79], v45
    s_setprio 1
    v_exp_f32 v50, v50
    v_exp_f32 v51, v51
    v_exp_f32 v52, v52
    v_exp_f32 v53, v53
    s_waitcnt lgkmcnt(0)
    v_mfma_f32_32x32x16_bf16 v[64:79], v[20:23], v[36:39], 0
    v_exp_f32 v54, v54
    v_exp_f32 v55, v55
    v_exp_f32 v56, v56
    v_exp_f32 v57, v57
    v_smfmac_f32_32x32x32_bf16 v[80:95], v[24:27], v[48:55], v45
    s_mov_b64 exec, s[58:59]
    ds_read_b128 v[24:27], v4 offset:64512
    ds_read_b128 v[32:35], v4 offset:65024
    s_mov_b64 exec, -1
    v_exp_f32 v58, v58
    v_exp_f32 v59, v59
    v_exp_f32 v60, v60
    v_exp_f32 v61, v61
    v_exp_f32 v62, v62
    v_exp_f32 v63, v63
    v_exp_f32 v64, v64
    v_exp_f32 v65, v65
    v_smfmac_f32_32x32x32_bf16 v[80:95], v[28:31], v[56:63], v45
    s_setprio 0
    v_exp_f32 v66, v66
    v_exp_f32 v67, v67
    v_exp_f32 v68, v68
    v_exp_f32 v69, v69
    s_waitcnt lgkmcnt(0)
    v_exp_f32 v70, v70
    v_exp_f32 v71, v71
    v_exp_f32 v72, v72
    v_exp_f32 v73, v73
    v_smfmac_f32_32x32x32_bf16 v[80:95], v[24:27], v[64:71], v45
    v_exp_f32 v74, v74
    v_exp_f32 v75, v75
    v_exp_f32 v76, v76
    v_exp_f32 v77, v77
    v_exp_f32 v78, v78
    v_exp_f32 v79, v79
    s_nop 1
    v_smfmac_f32_32x32x32_bf16 v[80:95], v[32:35], v[72:79], v45
    s_mov_b32 s28, 0x2b800000
    s_mov_b32 s29, 0x6f800000
    s_nop 9
    v_rcp_f32 v16, v88
    s_nop 0
    v_mul_f32 v16, v16, v44
    v_pk_mul_f32 v[80:81], v[80:81], v[16:17] op_sel_hi:[1,0]
    v_pk_mul_f32 v[82:83], v[82:83], v[16:17] op_sel_hi:[1,0]
    v_pk_mul_f32 v[84:85], v[84:85], v[16:17] op_sel_hi:[1,0]
    v_pk_mul_f32 v[86:87], v[86:87], v[16:17] op_sel_hi:[1,0]
    v_cvt_pk_bf16_f32 v20, v80, v81
    v_cvt_pk_bf16_f32 v21, v82, v83
    v_cvt_pk_bf16_f32 v22, v84, v85
    v_cvt_pk_bf16_f32 v23, v86, v87
    v_pk_add_f32 v[80:81], v[80:81], v[84:85]
    v_pk_add_f32 v[82:83], v[82:83], v[86:87]
    v_cmp_le_f32 s[60:61], s28, v88
    v_pk_add_f32 v[80:81], v[80:81], v[82:83]
    v_cmp_ge_f32 vcc, s29, v88
    v_add_f32 v80, v80, v81
    s_and_b64 s[60:61], vcc, s[60:61]
    v_mul_f32 v80, 0, v80
    v_cmp_o_f32 vcc, v80, v80
    s_nop 0
    s_and_b64 vcc, vcc, s[60:61]
    s_cmp_eq_u64 vcc, -1
    s_cbranch_scc0 L_exact
L_fin:
    v_min_u32 v20, -2, v20
    v_min_u32 v21, -2, v21
    v_min_u32 v22, -2, v22
    v_min_u32 v23, -2, v23
    buffer_store_dwordx4 v[20:23], v1, s[24:27], s43 offen sc1
    s_lshl_b32 s28, s71, 16
    s_lshl_b32 s29, s72, 11
    s_add_u32 s29, s29, s28
    v_add_u32 v24, s29, v1
    s_lshl_b32 s29, s72, 13
    s_add_u32 s29, s29, s28
    v_add_u32 v25, s29, v1
    v_and_b32 v26, 31, v0
    v_lshlrev_b32 v26, 10, v26
    v_lshrrev_b32 v27, 5, v0
    v_lshl_add_u32 v26, v27, 4, v26
    s_lshl_b32 s28, s74, 15
    s_lshl_b32 s29, s73, 7
    s_add_u32 s28, s28, s29
    s_lshl_b32 s29, s72, 5
    s_add_u32 s30, s28, s29
    v_add_u32 v6, s53, v6
    v_add_u32 v7, s53, v7
    s_waitcnt vmcnt(1)
    s_waitcnt lgkmcnt(0)
    s_barrier
    v_mfma_f32_32x32x16_bf16 v[128:143], v[160:163], v[96:99], 0
    ds_read_b64_tr_b16 v[28:29], v6 offset:0
    ds_read_b64_tr_b16 v[30:31], v6 offset:1024
    ds_read_b64_tr_b16 v[32:33], v7 offset:0
    v_mfma_f32_32x32x16_bf16 v[144:159], v[164:167], v[96:99], 0
    ds_read_b64_tr_b16 v[34:35], v7 offset:1024
    ds_read_b64_tr_b16 v[36:37], v6 offset:2048
    ds_read_b64_tr_b16 v[38:39], v6 offset:3072
    v_mfma_f32_32x32x16_bf16 v[128:143], v[168:171], v[100:103], v[128:143]
    ds_read_b64_tr_b16 v[40:41], v7 offset:2048
    ds_read_b64_tr_b16 v[42:43], v7 offset:3072
    ds_read_b64_tr_b16 v[80:81], v6 offset:4096
    v_mfma_f32_32x32x16_bf16 v[144:159], v[172:175], v[100:103], v[144:159]
    s_waitcnt lgkmcnt(11)
    ds_read_b64_tr_b16 v[82:83], v6 offset:5120
    ds_read_b64_tr_b16 v[84:85], v7 offset:4096
    ds_read_b64_tr_b16 v[86:87], v7 offset:5120
    v_mfma_f32_32x32x16_bf16 v[128:143], v[176:179], v[104:107], v[128:143]
    s_waitcnt lgkmcnt(11)
    ds_read_b64_tr_b16 v[88:89], v6 offset:6144
    ds_read_b64_tr_b16 v[90:91], v6 offset:7168
    ds_read_b64_tr_b16 v[92:93], v7 offset:6144
    v_mfma_f32_32x32x16_bf16 v[144:159], v[180:183], v[104:107], v[144:159]
    s_waitcnt lgkmcnt(11)
    ds_read_b64_tr_b16 v[94:95], v7 offset:7168
    ds_read_b64_tr_b16 v[228:229], v6 offset:8192
    ds_read_b64_tr_b16 v[230:231], v6 offset:9216
    s_add_u32 s3, s36, 0x0
    buffer_load_dwordx4 v[48:51], v1, s[24:27], s3 offen offset:0 sc1
    buffer_load_dwordx4 v[52:55], v1, s[24:27], s3 offen offset:1024 sc1
    buffer_load_dwordx4 v[56:59], v1, s[24:27], s3 offen offset:2048 sc1
    buffer_load_dwordx4 v[60:63], v1, s[24:27], s3 offen offset:3072 sc1
    s_add_u32 s3, s36, 0x1000
    buffer_load_dwordx4 v[64:67], v1, s[24:27], s3 offen offset:0 sc1
    buffer_load_dwordx4 v[68:71], v1, s[24:27], s3 offen offset:1024 sc1
    buffer_load_dwordx4 v[72:75], v1, s[24:27], s3 offen offset:2048 sc1
    buffer_load_dwordx4 v[76:79], v1, s[24:27], s3 offen offset:3072 sc1
    v_mfma_f32_32x32x16_bf16 v[128:143], v[184:187], v[108:111], v[128:143]
    s_waitcnt lgkmcnt(11)
    ds_read_b64_tr_b16 v[232:233], v7 offset:8192
    ds_read_b64_tr_b16 v[234:235], v7 offset:9216
    ds_read_b64_tr_b16 v[236:237], v6 offset:10240
    v_mfma_f32_32x32x16_bf16 v[144:159], v[188:191], v[108:111], v[144:159]
    s_waitcnt lgkmcnt(11)
    ds_read_b64_tr_b16 v[238:239], v6 offset:11264
    ds_read_b64_tr_b16 v[240:241], v7 offset:10240
    ds_read_b64_tr_b16 v[242:243], v7 offset:11264
    v_mfma_f32_32x32x16_bf16 v[128:143], v[192:195], v[112:115], v[128:143]
    s_waitcnt lgkmcnt(11)
    ds_read_b64_tr_b16 v[244:245], v6 offset:12288
    ds_read_b64_tr_b16 v[246:247], v6 offset:13312
    ds_read_b64_tr_b16 v[248:249], v7 offset:12288
    v_mfma_f32_32x32x16_bf16 v[144:159], v[196:199], v[112:115], v[144:159]
    s_waitcnt lgkmcnt(11)
    ds_read_b64_tr_b16 v[250:251], v7 offset:13312
    ds_read_b64_tr_b16 v[252:253], v6 offset:14336
    ds_read_b64_tr_b16 v[254:255], v6 offset:15360
    v_mfma_f32_32x32x16_bf16 v[128:143], v[200:203], v[116:119], v[128:143]
    s_waitcnt lgkmcnt(11)
    ds_read_b64_tr_b16 v[16:17], v7 offset:14336
    ds_read_b64_tr_b16 v[18:19], v7 offset:15360
    v_mfma_f32_32x32x16_bf16 v[144:159], v[204:207], v[116:119], v[144:159]
    v_mfma_f32_32x32x16_bf16 v[128:143], v[208:211], v[120:123], v[128:143]
    v_mfma_f32_32x32x16_bf16 v[144:159], v[212:215], v[120:123], v[144:159]
    v_mfma_f32_32x32x16_bf16 v[128:143], v[216:219], v[124:127], v[128:143]
    v_mfma_f32_32x32x16_bf16 v[144:159], v[220:223], v[124:127], v[144:159]
    s_mov_b32 s32, 65536
    s_waitcnt vmcnt(7)
L_val0:
    v_max3_u32 v8, v48, v49, v50
    v_max_u32 v8, v8, v51
    v_cmp_eq_u32 vcc, -1, v8
    s_cbranch_vccnz L_again0
L_got0:
    s_waitcnt lgkmcnt(0)
    v_mfma_f32_32x32x16_bf16 v[128:143], v[28:31], v[48:51], v[128:143]
    v_mfma_f32_32x32x16_bf16 v[144:159], v[32:35], v[48:51], v[144:159]
    s_waitcnt vmcnt(6)
L_val1:
    v_max3_u32 v8, v52, v53, v54
    v_max_u32 v8, v8, v55
    v_cmp_eq_u32 vcc, -1, v8
    s_cbranch_vccnz L_again1
L_got1:
    v_mfma_f32_32x32x16_bf16 v[128:143], v[36:39], v[52:55], v[128:143]
    v_mfma_f32_32x32x16_bf16 v[144:159], v[40:43], v[52:55], v[144:159]
    s_waitcnt vmcnt(5)
L_val2:
    v_max3_u32 v8, v56, v57, v58
    v_max_u32 v8, v8, v59
    v_cmp_eq_u32 vcc, -1, v8
    s_cbranch_vccnz L_again2
L_got2:
    v_mfma_f32_32x32x16_bf16 v[128:143], v[80:83], v[56:59], v[128:143]
    v_mfma_f32_32x32x16_bf16 v[144:159], v[84:87], v[56:59], v[144:159]
    s_waitcnt vmcnt(4)
L_val3:
    v_max3_u32 v8, v60, v61, v62
    v_max_u32 v8, v8, v63
    v_cmp_eq_u32 vcc, -1, v8
    s_cbranch_vccnz L_again3
L_got3:
    v_mfma_f32_32x32x16_bf16 v[128:143], v[88:91], v[60:63], v[128:143]
    v_mfma_f32_32x32x16_bf16 v[144:159], v[92:95], v[60:63], v[144:159]
    s_waitcnt vmcnt(3)
L_val4:
    v_max3_u32 v8, v64, v65, v66
    v_max_u32 v8, v8, v67
    v_cmp_eq_u32 vcc, -1, v8
    s_cbranch_vccnz L_again4
L_got4:
    v_mfma_f32_32x32x16_bf16 v[128:143], v[228:231], v[64:67], v[128:143]
    v_mfma_f32_32x32x16_bf16 v[144:159], v[232:235], v[64:67], v[144:159]
    s_waitcnt vmcnt(2)
L_val5:
    v_max3_u32 v8, v68, v69, v70
    v_max_u32 v8, v8, v71
    v_cmp_eq_u32 vcc, -1, v8
    s_cbranch_vccnz L_again5
L_got5:
    v_mfma_f32_32x32x16_bf16 v[128:143], v[236:239], v[68:71], v[128:143]
    v_mfma_f32_32x32x16_bf16 v[144:159], v[240:243], v[68:71], v[144:159]
    s_waitcnt vmcnt(1)
L_val6:
    v_max3_u32 v8, v72, v73, v74
    v_max_u32 v8, v8, v75
    v_cmp_eq_u32 vcc, -1, v8
    s_cbranch_vccnz L_again6
L_got6:
    v_mfma_f32_32x32x16_bf16 v[128:143], v[244:247], v[72:75], v[128:143]
    v_mfma_f32_32x32x16_bf16 v[144:159], v[248:251], v[72:75], v[144:159]
    s_waitcnt vmcnt(0)
L_val7:
    v_max3_u32 v8, v76, v77, v78
    v_max_u32 v8, v8, v79
    v_cmp_eq_u32 vcc, -1, v8
    s_cbranch_vccnz L_again7
L_got7:
    v_mfma_f32_32x32x16_bf16 v[128:143], v[252:255], v[76:79], v[128:143]
    v_mfma_f32_32x32x16_bf16 v[144:159], v[16:19], v[76:79], v[144:159]
    s_nop 10
    ds_write_b128 v24, v[128:131] offset:0
    ds_write_b128 v24, v[132:135] offset:1024
    ds_write_b128 v24, v[136:139] offset:8192
    ds_write_b128 v24, v[140:143] offset:9216
    ds_write_b128 v24, v[144:147] offset:16384
    ds_write_b128 v24, v[148:151] offset:17408
    ds_write_b128 v24, v[152:155] offset:24576
    ds_write_b128 v24, v[156:159] offset:25600
    s_waitcnt lgkmcnt(0)
    s_barrier
    ds_read_b128 v[48:51], v25 offset:0
    ds_read_b128 v[52:55], v25 offset:1024
    ds_read_b128 v[56:59], v25 offset:2048
    ds_read_b128 v[60:63], v25 offset:3072
    ds_read_b128 v[64:67], v25 offset:4096
    ds_read_b128 v[68:71], v25 offset:5120
    ds_read_b128 v[72:75], v25 offset:6144
    ds_read_b128 v[76:79], v25 offset:7168
    s_waitcnt lgkmcnt(4)
    v_pk_add_f32 v[48:49], v[48:49], v[56:57]
    v_pk_add_f32 v[50:51], v[50:51], v[58:59]
    v_pk_add_f32 v[52:53], v[52:53], v[60:61]
    v_pk_add_f32 v[54:55], v[54:55], v[62:63]
    s_waitcnt lgkmcnt(0)
    v_pk_add_f32 v[64:65], v[64:65], v[72:73]
    v_pk_add_f32 v[66:67], v[66:67], v[74:75]
    v_pk_add_f32 v[68:69], v[68:69], v[76:77]
    v_pk_add_f32 v[70:71], v[70:71], v[78:79]
    v_pk_add_f32 v[48:49], v[48:49], v[64:65]
    v_pk_add_f32 v[50:51], v[50:51], v[66:67]
    v_pk_add_f32 v[52:53], v[52:53], v[68:69]
    v_pk_add_f32 v[54:55], v[54:55], v[70:71]
    v_cvt_pk_bf16_f32 v20, v48, v49
    v_cvt_pk_bf16_f32 v21, v50, v51
    v_cvt_pk_bf16_f32 v22, v52, v53
    v_cvt_pk_bf16_f32 v23, v54, v55
    buffer_store_dwordx4 v[20:23], v26, s[20:23], s30 offen
L_done:
    s_endpgm
L_again0:
    s_sub_u32 s32, s32, 1
    s_cselect_b32 s32, 0, s32
    s_cbranch_scc1 L_got0
    s_add_u32 s3, s36, 0x0
    buffer_load_dwordx4 v[48:51], v1, s[24:27], s3 offen offset:0 sc1
    buffer_load_dwordx4 v[52:55], v1, s[24:27], s3 offen offset:1024 sc1
    buffer_load_dwordx4 v[56:59], v1, s[24:27], s3 offen offset:2048 sc1
    buffer_load_dwordx4 v[60:63], v1, s[24:27], s3 offen offset:3072 sc1
    s_add_u32 s3, s36, 0x1000
    buffer_load_dwordx4 v[64:67], v1, s[24:27], s3 offen offset:0 sc1
    buffer_load_dwordx4 v[68:71], v1, s[24:27], s3 offen offset:1024 sc1
    buffer_load_dwordx4 v[72:75], v1, s[24:27], s3 offen offset:2048 sc1
    buffer_load_dwordx4 v[76:79], v1, s[24:27], s3 offen offset:3072 sc1
    s_waitcnt vmcnt(0)
    s_branch L_val0
L_again1:
    s_sub_u32 s32, s32, 1
    s_cselect_b32 s32, 0, s32
    s_cbranch_scc1 L_got1
    s_add_u32 s3, s36, 0x0
    buffer_load_dwordx4 v[52:55], v1, s[24:27], s3 offen offset:1024 sc1
    buffer_load_dwordx4 v[56:59], v1, s[24:27], s3 offen offset:2048 sc1
    buffer_load_dwordx4 v[60:63], v1, s[24:27], s3 offen offset:3072 sc1
    s_add_u32 s3, s36, 0x1000
    buffer_load_dwordx4 v[64:67], v1, s[24:27], s3 offen offset:0 sc1
    buffer_load_dwordx4 v[68:71], v1, s[24:27], s3 offen offset:1024 sc1
    buffer_load_dwordx4 v[72:75], v1, s[24:27], s3 offen offset:2048 sc1
    buffer_load_dwordx4 v[76:79], v1, s[24:27], s3 offen offset:3072 sc1
    s_waitcnt vmcnt(0)
    s_branch L_val1
L_again2:
    s_sub_u32 s32, s32, 1
    s_cselect_b32 s32, 0, s32
    s_cbranch_scc1 L_got2
    s_add_u32 s3, s36, 0x0
    buffer_load_dwordx4 v[56:59], v1, s[24:27], s3 offen offset:2048 sc1
    buffer_load_dwordx4 v[60:63], v1, s[24:27], s3 offen offset:3072 sc1
    s_add_u32 s3, s36, 0x1000
    buffer_load_dwordx4 v[64:67], v1, s[24:27], s3 offen offset:0 sc1
    buffer_load_dwordx4 v[68:71], v1, s[24:27], s3 offen offset:1024 sc1
    buffer_load_dwordx4 v[72:75], v1, s[24:27], s3 offen offset:2048 sc1
    buffer_load_dwordx4 v[76:79], v1, s[24:27], s3 offen offset:3072 sc1
    s_waitcnt vmcnt(0)
    s_branch L_val2
L_again3:
    s_sub_u32 s32, s32, 1
    s_cselect_b32 s32, 0, s32
    s_cbranch_scc1 L_got3
    s_add_u32 s3, s36, 0x0
    buffer_load_dwordx4 v[60:63], v1, s[24:27], s3 offen offset:3072 sc1
    s_add_u32 s3, s36, 0x1000
    buffer_load_dwordx4 v[64:67], v1, s[24:27], s3 offen offset:0 sc1
    buffer_load_dwordx4 v[68:71], v1, s[24:27], s3 offen offset:1024 sc1
    buffer_load_dwordx4 v[72:75], v1, s[24:27], s3 offen offset:2048 sc1
    buffer_load_dwordx4 v[76:79], v1, s[24:27], s3 offen offset:3072 sc1
    s_waitcnt vmcnt(0)
    s_branch L_val3
L_again4:
    s_sub_u32 s32, s32, 1
    s_cselect_b32 s32, 0, s32
    s_cbranch_scc1 L_got4
    s_add_u32 s3, s36, 0x1000
    buffer_load_dwordx4 v[64:67], v1, s[24:27], s3 offen offset:0 sc1
    buffer_load_dwordx4 v[68:71], v1, s[24:27], s3 offen offset:1024 sc1
    buffer_load_dwordx4 v[72:75], v1, s[24:27], s3 offen offset:2048 sc1
    buffer_load_dwordx4 v[76:79], v1, s[24:27], s3 offen offset:3072 sc1
    s_waitcnt vmcnt(0)
    s_branch L_val4
L_again5:
    s_sub_u32 s32, s32, 1
    s_cselect_b32 s32, 0, s32
    s_cbranch_scc1 L_got5
    s_add_u32 s3, s36, 0x1000
    buffer_load_dwordx4 v[68:71], v1, s[24:27], s3 offen offset:1024 sc1
    buffer_load_dwordx4 v[72:75], v1, s[24:27], s3 offen offset:2048 sc1
    buffer_load_dwordx4 v[76:79], v1, s[24:27], s3 offen offset:3072 sc1
    s_waitcnt vmcnt(0)
    s_branch L_val5
L_again6:
    s_sub_u32 s32, s32, 1
    s_cselect_b32 s32, 0, s32
    s_cbranch_scc1 L_got6
    s_add_u32 s3, s36, 0x1000
    buffer_load_dwordx4 v[72:75], v1, s[24:27], s3 offen offset:2048 sc1
    buffer_load_dwordx4 v[76:79], v1, s[24:27], s3 offen offset:3072 sc1
    s_waitcnt vmcnt(0)
    s_branch L_val6
L_again7:
    s_sub_u32 s32, s32, 1
    s_cselect_b32 s32, 0, s32
    s_cbranch_scc1 L_got7
    s_add_u32 s3, s36, 0x1000
    buffer_load_dwordx4 v[76:79], v1, s[24:27], s3 offen offset:3072 sc1
    s_waitcnt vmcnt(0)
    s_branch L_val7
L_exact:
    s_lshl_b32 s29, s35, 16
    v_add_u32 v8, s29, v1
    v_mov_b32 v9, 0xff800000
    s_mov_b32 s28, 0x200000
L_max:
    buffer_load_dwordx4 v[16:19], v8, s[24:27], s28 offen sc1
    s_add_u32 s28, s28, 0x400
    s_waitcnt vmcnt(0)
    v_mfma_f32_32x32x16_bf16 v[48:63], v[16:19], v[36:39], 0
    s_nop 11
    v_max3_f32 v9, v9, v48, v49
    v_max3_f32 v9, v9, v50, v51
    v_max3_f32 v9, v9, v52, v53
    v_max3_f32 v9, v9, v54, v55
    v_max3_f32 v9, v9, v56, v57
    v_max3_f32 v9, v9, v58, v59
    v_max3_f32 v9, v9, v60, v61
    v_max3_f32 v9, v9, v62, v63
    s_cmp_lg_u32 s28, 0x210000
    s_cbranch_scc1 L_max
    v_mov_b32 v20, v9
    s_nop 1
    v_permlane32_swap_b32 v9, v20
    v_max_f32 v9, v9, v20
    v_sub_f32 v64, 0, v9
    v_mov_b32 v80, 0
    v_sub_f32 v65, 0, v9
    v_mov_b32 v81, 0
    v_sub_f32 v66, 0, v9
    v_mov_b32 v82, 0
    v_sub_f32 v67, 0, v9
    v_mov_b32 v83, 0
    v_sub_f32 v68, 0, v9
    v_mov_b32 v84, 0
    v_sub_f32 v69, 0, v9
    v_mov_b32 v85, 0
    v_sub_f32 v70, 0, v9
    v_mov_b32 v86, 0
    v_sub_f32 v71, 0, v9
    v_mov_b32 v87, 0
    v_sub_f32 v72, 0, v9
    v_mov_b32 v88, 0
    v_sub_f32 v73, 0, v9
    v_mov_b32 v89, 0
    v_sub_f32 v74, 0, v9
    v_mov_b32 v90, 0
    v_sub_f32 v75, 0, v9
    v_mov_b32 v91, 0
    v_sub_f32 v76, 0, v9
    v_mov_b32 v92, 0
    v_sub_f32 v77, 0, v9
    v_mov_b32 v93, 0
    v_sub_f32 v78, 0, v9
    v_mov_b32 v94, 0
    v_sub_f32 v79, 0, v9
    v_mov_b32 v95, 0
    s_add_u32 s29, s29, 0x1f0000
    v_add_u32 v9, s29, v4
    s_mov_b32 s28, 0x200000
L_sum:
    buffer_load_dwordx4 v[16:19], v8, s[24:27], s28 offen sc1
    s_mov_b64 exec, s[58:59]
    buffer_load_dwordx4 v[24:27], v9, s[24:27], s28 offen sc1
    buffer_load_dwordx4 v[28:31], v9, s[24:27], s28 offen offset:512 sc1
    s_mov_b64 exec, -1
    s_add_u32 s28, s28, 0x400
    s_waitcnt vmcnt(0)
    v_mfma_f32_32x32x16_bf16 v[48:63], v[16:19], v[36:39], v[64:79]
    s_nop 11
    v_exp_f32 v48, v48
    v_exp_f32 v49, v49
    v_exp_f32 v50, v50
    v_exp_f32 v51, v51
    v_exp_f32 v52, v52
    v_exp_f32 v53, v53
    v_exp_f32 v54, v54
    v_exp_f32 v55, v55
    v_exp_f32 v56, v56
    v_exp_f32 v57, v57
    v_exp_f32 v58, v58
    v_exp_f32 v59, v59
    v_exp_f32 v60, v60
    v_exp_f32 v61, v61
    v_exp_f32 v62, v62
    v_exp_f32 v63, v63
    v_smfmac_f32_32x32x32_bf16 v[80:95], v[24:27], v[48:55], v45
    s_nop 0
    v_smfmac_f32_32x32x32_bf16 v[80:95], v[28:31], v[56:63], v45
    s_cmp_lg_u32 s28, 0x210000
    s_cbranch_scc1 L_sum
    s_nop 9
    v_rcp_f32 v16, v88
    s_nop 0
    v_mul_f32 v16, v16, v44
    v_pk_mul_f32 v[80:81], v[80:81], v[16:17] op_sel_hi:[1,0]
    v_pk_mul_f32 v[82:83], v[82:83], v[16:17] op_sel_hi:[1,0]
    v_pk_mul_f32 v[84:85], v[84:85], v[16:17] op_sel_hi:[1,0]
    v_pk_mul_f32 v[86:87], v[86:87], v[16:17] op_sel_hi:[1,0]
    v_cvt_pk_bf16_f32 v20, v80, v81
    v_cvt_pk_bf16_f32 v21, v82, v83
    v_cvt_pk_bf16_f32 v22, v84, v85
    v_cvt_pk_bf16_f32 v23, v86, v87
    s_branch L_fin
L_end:
.section .rodata,"a"
.p2align 6
.amdhsa_kernel gated_mix__mha_block__linear_attn_block__prompt_kernel
  .amdhsa_next_free_vgpr 256
  .amdhsa_next_free_sgpr 102
  .amdhsa_accum_offset 256
  .amdhsa_group_segment_fixed_size 0
  .amdhsa_kernarg_size 80
  .amdhsa_user_sgpr_count 2
  .amdhsa_user_sgpr_kernarg_segment_ptr 1
  .amdhsa_system_sgpr_workgroup_id_x 1
.end_amdhsa_kernel
```
